```python
import torch

def _softmax(x, axis=-1):
    return torch.softmax(x, dim=axis)
def _gelu(x):
    return torch.nn.functional.gelu(x, approximate="tanh")
def _silu(x):
    return torch.nn.functional.silu(x)
def _sigmoid(x):
    return torch.sigmoid(x)
def _layernorm(x, axis=-1, eps=1e-5):
    m = x.mean(dim=axis, keepdim=True)
    v = x.var(dim=axis, keepdim=True, unbiased=False)
    return (x - m) / torch.sqrt(v + eps)
def _scatter_add(tgt, idx, src, axis=0):
    return tgt.clone().index_add_(axis, idx, src)
def _segment_sum(src, seg, n):
    out = torch.zeros((n,) + src.shape[1:], dtype=src.dtype)
    return out.index_add_(0, seg, src)
def _pad(x, pw):
    flat = tuple(v for pair in reversed(pw) for v in pair)
    return torch.nn.functional.pad(x, flat)

kernel_name = 'concat_heads__softmax_full_mha__ssm_conv_s5__prompt'

def setup_inputs():

    _w = (lambda a: (lambda t: t.to(torch.bfloat16) if t.is_floating_point() else t)(torch.as_tensor(a)))
    def _A_setup():
        B, S, D = 1, 2048, 640
        return {
            "x": _w((lambda *s: torch.randn(*s, dtype=torch.bfloat16) * 0.2)(B, S, D)),
            "wqkv": _w((lambda *s: torch.randn(*s, dtype=torch.bfloat16) * 0.2)(D, 3 * D)),
            "wo": _w((lambda *s: torch.randn(*s, dtype=torch.bfloat16) * 0.05)(D, D)),
        }
    _A_in = _A_setup()

    def _B_setup():
        B, S, D = 1, 2048, 640
        P = D
        Lambda_re = -0.5 * (lambda _x: torch.exp(torch.as_tensor(_x)))((lambda *s: torch.randn(*s, dtype=torch.bfloat16) * 0.8)(P))
        Lambda_im = (lambda *s: torch.randn(*s, dtype=torch.bfloat16) * 0.8)(P) * 1.0
        B_re = (lambda *s: torch.randn(*s, dtype=torch.bfloat16) * 0.8)(P, D) * (D ** -0.5)
        B_im = (lambda *s: torch.randn(*s, dtype=torch.bfloat16) * 0.8)(P, D) * (D ** -0.5)
        C_re = (lambda *s: torch.randn(*s, dtype=torch.bfloat16) * 0.8)(D, P) * (P ** -0.5)
        C_im = (lambda *s: torch.randn(*s, dtype=torch.bfloat16) * 0.8)(D, P) * (P ** -0.5)
        log_dt = (lambda *s: torch.randn(*s, dtype=torch.bfloat16) * 0.8)(P) * 0.3 - 2.0
        Dskip = (lambda *s: torch.randn(*s, dtype=torch.bfloat16) * 0.8)(D)
        return {
            "x": _w((lambda *s: torch.randn(*s, dtype=torch.bfloat16) * 0.05)(B, S, D)),
            "Lambda_re": _w(Lambda_re),
            "Lambda_im": _w(Lambda_im),
            "B_re": _w(B_re),
            "B_im": _w(B_im),
            "C_re": _w(C_re),
            "C_im": _w(C_im),
            "log_dt": _w(log_dt),
            "Dskip": _w(Dskip),
        }
    _B_in = _B_setup()

    return {
        "A_x": _A_in["x"],
        "A_wqkv": _A_in["wqkv"],
        "A_wo": _A_in["wo"],
        "B_x": _B_in["x"],
        "B_Lambda_re": _B_in["Lambda_re"],
        "B_Lambda_im": _B_in["Lambda_im"],
        "B_B_re": _B_in["B_re"],
        "B_B_im": _B_in["B_im"],
        "B_C_re": _B_in["C_re"],
        "B_C_im": _B_in["C_im"],
        "B_log_dt": _B_in["log_dt"],
        "B_Dskip": _B_in["Dskip"],
    }

def reference(A_x, A_wqkv, A_wo, B_x, B_Lambda_re, B_Lambda_im, B_B_re, B_B_im, B_C_re, B_C_im, B_log_dt, B_Dskip):
    def _A_ref(x, wqkv, wo):
        B, S, D = x.shape
        H = 32; Dh = D // H
        qkv = (lambda x, *d: x.permute(*d))((x @ wqkv).reshape(B, S, 3, H, Dh), 2, 0, 3, 1, 4)
        q, k, v = qkv[0], qkv[1], qkv[2]
        scale = Dh ** -0.5
        scores = torch.einsum("bhqd,bhkd->bhqk", q, k) * scale
        p = _softmax(scores, axis=-1)
        o = torch.einsum("bhqk,bhkd->bhqd", p, v)
        return (lambda x, *d: x.permute(*d))(o, 0, 2, 1, 3).reshape(B, S, D) @ wo

    def _B_ref(x, Lambda_re, Lambda_im, B_re, B_im, C_re, C_im, log_dt, Dskip):
        Bsz, L, H = x.shape
        Lam = Lambda_re + 1j * Lambda_im
        Bmat = B_re + 1j * B_im
        Cmat = C_re + 1j * C_im
        dt = torch.exp(log_dt)
        Lam_bar = torch.exp(dt * Lam)
        B_bar = ((Lam_bar - 1.0) / Lam)[:, None] * Bmat
        Bu = torch.einsum("bld,pd->blp", x + 0j, B_bar)
        h = torch.zeros_like(Bu[:, 0, :])
        hs = []
        for t in range(L):
            h = Lam_bar[None, :] * h + Bu[:, t, :]
            hs.append(h)
        hseq = torch.stack(hs, 1)
        y = 2.0 * torch.einsum("blp,dp->bld", hseq, Cmat).real + x * Dskip[None, None, :]
        return y

    a = _A_ref(A_x, A_wqkv, A_wo)
    b = _B_ref(B_x, B_Lambda_re, B_Lambda_im, B_B_re, B_B_im, B_C_re, B_C_im, B_log_dt, B_Dskip)
    return torch.concatenate([a, b], axis=-1)
```

```asm
; @launch grid=(256,1,1) block=(512,1,1) lds=163840
.amdgcn_target "amdgcn-amd-amdhsa--gfx950"
.text
.globl concat_heads__softmax_full_mha__ssm_conv_s5__prompt_kernel
.p2align 8
.type concat_heads__softmax_full_mha__ssm_conv_s5__prompt_kernel,@function
concat_heads__softmax_full_mha__ssm_conv_s5__prompt_kernel:
PK_BEGIN:
    s_cmp_ge_u32 s2, 256
    s_cbranch_scc1 PK_END
    s_load_dwordx2 s[4:5], s[0:1], 0
    s_load_dwordx2 s[8:9], s[0:1], 8
    v_lshrrev_b32 v1, 6, v0
    s_and_b32 s39, s2, 7
    s_lshr_b32 s48, s2, 3
    v_readfirstlane_b32 s38, v1
    s_lshr_b32 s56, s39, 1
    s_mul_i32 s56, s56, 32
    s_add_u32 s56, s56, s48
    s_and_b32 s49, s39, 1
    s_lshl_b32 s49, s49, 3
    s_and_b32 s57, s56, 7
    s_add_u32 s49, s49, s57
    s_lshr_b32 s50, s56, 3
    v_and_b32 v1, 63, v0
    s_cmp_lt_u32 s38, 4
    s_cbranch_scc1 PK_COMPUTE
    s_mov_b32 s6, 2621440
    s_mov_b32 s7, 0x00020000
    s_mov_b32 s10, 2457600
    s_mov_b32 s11, 0x00020000
    s_sub_u32 s98, s38, 4
    v_lshrrev_b32 v2, 4, v1
    v_and_b32 v3, 7, v1
    v_xor_b32 v3, v3, v2
    v_lshlrev_b32 v3, 4, v3
    v_lshrrev_b32 v2, 3, v1
    v_mul_u32_u24 v2, 1280, v2
    v_add_u32 v10, v2, v3
    v_xor_b32 v11, 64, v10
    v_lshrrev_b32 v2, 4, v1
    v_and_b32 v3, 15, v1
    v_lshlrev_b32 v4, 2, v2
    v_xor_b32 v3, v3, v4
    v_lshlrev_b32 v3, 4, v3
    v_mul_u32_u24 v2, 3840, v2
    v_add_u32 v12, v2, v3
    s_lshr_b32 s75, s48, 3
    s_mul_i32 s75, s75, 6
    s_lshr_b32 s75, s75, 1
    s_add_u32 s75, s75, s57
    s_sub_u32 s56, s75, 10
    s_cmp_ge_u32 s75, 10
    s_cselect_b32 s75, s56, s75
    s_lshl_b32 s99, s49, 2
    s_add_u32 s99, s99, s98
    s_mul_i32 s99, s99, 40960
    s_lshl_b32 s56, s75, 7
    s_add_u32 s99, s99, s56
    s_lshl_b32 s100, s75, 2
    s_add_u32 s100, s100, s98
    s_mul_i32 s100, s100, 61440
    s_lshl_b32 s56, s50, 8
    s_add_u32 s100, s100, s56
    s_lshl_b32 s101, s98, 12
    s_add_u32 s3, s101, 4*32768
    s_cmp_eq_u32 s50, 15
    s_waitcnt lgkmcnt(0)
    s_cbranch_scc1 L_LATE
    s_mov_b32 m0, s101
    s_mov_b32 s53, 0
L_P:
    buffer_load_dwordx4 v10, s[4:7], s99 offen lds
    s_add_u32 s75, s75, 1
    s_cmp_eq_u32 s75, 10
    s_cselect_b32 s75, 0, s75
    s_cselect_b32 s94, -9, 1
    s_add_u32 m0, s101, 1024
    s_add_u32 s56, s99, 10240
    buffer_load_dwordx4 v11, s[4:7], s56 offen lds
    s_mul_i32 s95, s94, 245760
    s_add_u32 s95, s95, s100
    s_add_u32 s53, s53, 1
    s_add_u32 m0, s101, 2048
    s_add_u32 s56, s99, 20480
    buffer_load_dwordx4 v10, s[4:7], s56 offen lds
    s_add_u32 s91, s101, 32768
    s_cmp_eq_u32 s91, s3
    s_cselect_b32 s57, 131072, 0
    s_sub_u32 s91, s91, s57
    s_add_u32 m0, s101, 3072
    s_add_u32 s56, s99, 30720
    buffer_load_dwordx4 v11, s[4:7], s56 offen lds
    s_lshl_b32 s94, s94, 7
    s_add_u32 s99, s99, s94
    s_add_u32 m0, s101, 16384
    s_nop 0
    buffer_load_dwordx4 v12, s[8:11], s100 offen lds
    s_add_u32 m0, s101, 17408
    s_add_u32 s56, s100, 15360
    buffer_load_dwordx4 v12, s[8:11], s56 offen lds
    s_add_u32 m0, s101, 18432
    s_add_u32 s56, s100, 30720
    buffer_load_dwordx4 v12, s[8:11], s56 offen lds
    s_add_u32 m0, s101, 19456
    s_add_u32 s56, s100, 46080
    s_mov_b32 s100, s95
    s_mov_b32 s101, s91
    buffer_load_dwordx4 v12, s[8:11], s56 offen lds
    s_mov_b32 m0, s101
    s_cmp_lt_u32 s53, 2
    s_cbranch_scc1 L_P
L_LATE:
    s_load_dwordx2 s[12:13], s[0:1], 112
    s_load_dwordx2 s[16:17], s[0:1], 24
    s_load_dwordx2 s[28:29], s[0:1], 16
    s_load_dwordx2 s[32:33], s[0:1], 96
    s_load_dwordx2 s[36:37], s[0:1], 104
    s_load_dwordx4 s[40:43], s[0:1], 32
    s_load_dwordx4 s[44:47], s[0:1], 80
    s_sub_u32 s56, s48, 20
    s_cmp_lt_u32 s48, 20
    s_cselect_b32 s56, s48, s56
    s_cselect_b32 s57, 48, 64
    s_load_dwordx2 s[20:21], s[0:1], s57
    s_cbranch_scc1 L_UMAP
    s_and_b32 s51, s56, 1
    s_lshl_b32 s58, s39, 1
    s_add_u32 s51, s51, s58
    s_lshr_b32 s52, s56, 1
    s_branch L_MAPPED
L_UMAP:
    s_and_b32 s51, s56, 3
    s_lshr_b32 s58, s39, 1
    s_lshl_b32 s58, s58, 2
    s_add_u32 s51, s51, s58
    s_lshr_b32 s52, s56, 2
    s_and_b32 s58, s39, 1
    s_mul_i32 s58, s58, 5
    s_add_u32 s52, s52, s58
L_MAPPED:
    s_add_u32 s57, s57, 8
    s_load_dwordx2 s[24:25], s[0:1], s57
    v_and_b32 v14, 31, v1
    v_lshrrev_b32 v15, 5, v1
    s_getpc_b64 s[92:93]
L_PC:
    s_sub_u32 s92, s92, L_PC-PK_BEGIN
    s_subb_u32 s93, s93, 0
    s_mov_b32 s14, 16187392
    s_mov_b32 s15, 0x00020000
    s_mov_b32 s18, 2621440
    s_mov_b32 s19, 0x00020000
    s_mov_b32 s30, 819200
    s_mov_b32 s31, 0x00020000
    s_mov_b32 s34, 10485760
    s_mov_b32 s35, 0x00020000
    s_mov_b32 s22, 819200
    s_mov_b32 s23, 0x00020000
    s_mov_b32 s26, 819200
    s_mov_b32 s27, 0x00020000
    v_mov_b32 v6, 0
    v_mov_b32 v7, 0
    v_mov_b32 v120, 0
    v_mov_b32 v121, 0
    v_mov_b32 v122, 0
    v_mov_b32 v242, 0
    v_mov_b32 v227, 0
    v_mov_b32 v230, 0
    v_mov_b32 v231, 0
    v_mov_b32 v234, 0
    v_mov_b32 v235, 0
    v_mov_b32 v240, 0
    v_mov_b32 v241, 0
    v_mov_b32 v248, 0
    v_mov_b32 v253, 0
    v_mov_b32 v254, 0
    v_mov_b32 v16, 0x3f803f80
    v_mov_b32 v17, v16
    v_mov_b32 v18, v16
    v_mov_b32 v19, v16
    v_mov_b32 v20, 0
    v_mov_b32 v21, 0
    v_mov_b32 v22, 0
    v_mov_b32 v23, 0
    v_mul_u32_u24 v2, 640, v1
    v_add_u32 v2, 153600, v2
    s_mul_i32 s56, s98, 1280
    s_add_u32 s56, s56, 153968
    v_lshl_add_u32 v3, v1, 2, s56
    ds_write_b32 v3, v20
    ds_write_b32 v3, v20 offset:640
    s_mov_b64 exec, 0xffff
    ds_write_b128 v2, v[16:19] offset:128
    ds_write_b128 v2, v[20:23] offset:144
    ds_write_b128 v2, v[20:23] offset:192
    ds_write_b128 v2, v[20:23]
    ds_write_b32 v2, v20 offset:352
    ds_write_b128 v2, v[20:23] offset:336
    s_mov_b64 exec, -1
    v_lshlrev_b32 v2, 5, v15
    v_bfe_u32 v3, v1, 3, 2
    v_add_u32 v2, v2, v3
    v_mul_u32_u24 v2, 1280, v2
    v_and_b32 v3, 0x70, v10
    v_add_u32 v8, v2, v3
    v_xor_b32 v9, 64, v8
    s_and_b32 s56, s48, 3
    s_mul_i32 s56, s56, 3
    s_lshr_b32 s58, s48, 2
    s_lshl_b32 s58, s58, 1
    s_add_u32 s90, s56, s58
    s_sub_u32 s56, s90, 10
    s_cmp_ge_u32 s90, 10
    s_cselect_b32 s90, s56, s90
    s_lshl_b32 s59, s90, 7
    s_lshl_b32 s88, s51, 7
    s_lshr_b32 s56, s98, 1
    s_lshl_b32 s57, s56, 6
    s_add_u32 s88, s88, s57
    s_and_b32 s57, s98, 1
    s_lshl_b32 s58, s57, 4
    s_add_u32 s88, s88, s58
    s_mul_i32 s88, s88, 1280
    s_add_u32 s88, s88, s59
    s_lshl_b32 s89, s52, 6
    s_lshl_b32 s56, s56, 5
    s_add_u32 s89, s89, s56
    s_mul_i32 s89, s89, 1280
    s_add_u32 s89, s89, s59
    s_cmp_lt_u32 s48, 20
    s_cselect_b32 s57, s57, 0
    s_cmp_eq_u32 s57, 0
    s_waitcnt lgkmcnt(0)
    s_cbranch_scc1 L_URE
    s_mov_b32 s20, s24
    s_mov_b32 s21, s25
L_URE:
    s_cmp_eq_u32 s50, 15
    s_cbranch_scc1 L_SETUP
    s_waitcnt vmcnt(8)
    s_barrier
L_Q:
    buffer_load_dwordx4 v10, s[4:7], s99 offen lds
    s_add_u32 s75, s75, 1
    s_cmp_eq_u32 s75, 10
    s_cselect_b32 s75, 0, s75
    s_cselect_b32 s94, -9, 1
    s_add_u32 m0, s101, 1024
    s_add_u32 s56, s99, 10240
    buffer_load_dwordx4 v11, s[4:7], s56 offen lds
    s_mul_i32 s95, s94, 245760
    s_add_u32 s95, s95, s100
    s_add_u32 s53, s53, 1
    s_add_u32 m0, s101, 2048
    s_add_u32 s56, s99, 20480
    buffer_load_dwordx4 v10, s[4:7], s56 offen lds
    s_add_u32 s91, s101, 32768
    s_cmp_eq_u32 s91, s3
    s_cselect_b32 s57, 131072, 0
    s_sub_u32 s91, s91, s57
    s_add_u32 m0, s101, 3072
    s_add_u32 s56, s99, 30720
    buffer_load_dwordx4 v11, s[4:7], s56 offen lds
    s_lshl_b32 s94, s94, 7
    s_add_u32 s99, s99, s94
    s_add_u32 m0, s101, 16384
    s_nop 0
    buffer_load_dwordx4 v12, s[8:11], s100 offen lds
    s_add_u32 m0, s101, 17408
    s_add_u32 s56, s100, 15360
    buffer_load_dwordx4 v12, s[8:11], s56 offen lds
    s_add_u32 m0, s101, 18432
    s_add_u32 s56, s100, 30720
    buffer_load_dwordx4 v12, s[8:11], s56 offen lds
    s_add_u32 m0, s101, 19456
    s_add_u32 s56, s100, 46080
    s_mov_b32 s100, s95
    s_mov_b32 s101, s91
    buffer_load_dwordx4 v12, s[8:11], s56 offen lds
    s_mov_b32 m0, s101
    s_cmp_lt_u32 s53, 4
    s_cbranch_scc1 L_Q
    s_cmp_lt_u32 s53, 10
    s_waitcnt vmcnt(16)
    s_barrier
    s_cbranch_scc1 L_Q
    s_cmp_ge_u32 s48, 20
    s_cbranch_scc1 L_NU
    s_mov_b32 s99, s88
    s_mov_b32 s100, s89
    s_mov_b32 s75, s90
    s_mov_b32 s53, 0
L_U1:
    buffer_load_dwordx4 v8, s[16:19], s99 offen lds
    s_add_u32 s75, s75, 1
    s_cmp_eq_u32 s75, 10
    s_cselect_b32 s75, 0, s75
    s_cselect_b32 s94, -9, 1
    s_add_u32 m0, s101, 1024
    s_add_u32 s56, s99, 5120
    buffer_load_dwordx4 v9, s[16:19], s56 offen lds
    s_mul_i32 s95, s94, 128
    s_add_u32 s95, s95, s100
    s_add_u32 s53, s53, 1
    s_add_u32 m0, s101, 2048
    s_add_u32 s56, s99, 10240
    buffer_load_dwordx4 v8, s[16:19], s56 offen lds
    s_add_u32 s91, s101, 32768
    s_cmp_eq_u32 s91, s3
    s_cselect_b32 s57, 131072, 0
    s_sub_u32 s91, s91, s57
    s_add_u32 m0, s101, 3072
    s_add_u32 s56, s99, 15360
    buffer_load_dwordx4 v9, s[16:19], s56 offen lds
    s_lshl_b32 s94, s94, 7
    s_add_u32 s99, s99, s94
    s_add_u32 m0, s101, 16384
    s_nop 0
    buffer_load_dwordx4 v10, s[20:23], s100 offen lds
    s_add_u32 m0, s101, 17408
    s_add_u32 s56, s100, 10240
    buffer_load_dwordx4 v11, s[20:23], s56 offen lds
    s_add_u32 m0, s101, 18432
    s_add_u32 s56, s100, 20480
    buffer_load_dwordx4 v10, s[20:23], s56 offen lds
    s_add_u32 m0, s101, 19456
    s_add_u32 s56, s100, 30720
    s_mov_b32 s100, s95
    s_mov_b32 s101, s91
    buffer_load_dwordx4 v11, s[20:23], s56 offen lds
    s_mov_b32 m0, s101
    s_cmp_lt_u32 s53, 5
    s_cbranch_scc1 L_USP
    s_cmp_lt_u32 s53, 10
    s_waitcnt vmcnt(16)
    s_barrier
    s_cbranch_scc1 L_U1
    s_branch L_ATT
L_USP:
    s_cmp_eq_u32 s53, 1
    s_cbranch_scc1 L_U2
    s_cmp_lg_u32 s53, 3
    s_cbranch_scc1 L_U1
    s_waitcnt vmcnt(8)
    s_barrier
    s_branch L_U1
L_U2:
    s_waitcnt vmcnt(16)
    s_barrier
    s_waitcnt vmcnt(8)
    s_barrier
    s_branch L_SETUP
L_NU:
    s_waitcnt vmcnt(8)
    s_barrier
    s_waitcnt vmcnt(0)
    s_barrier
L_SETUP:
    s_lshl_b32 s4, s39, 2
    s_and_b32 s56, s48, 3
    s_add_u32 s4, s4, s56
    s_lshr_b32 s5, s48, 2
    s_lshr_b32 s56, s4, 1
    s_mul_i32 s56, s56, 5
    s_and_b32 s6, s4, 1
    s_mul_i32 s7, s6, 3
    s_add_u32 s7, s7, s56
    s_add_u32 s8, s56, 2
    s_lshl_b32 s9, s5, 12
    s_lshl_b32 s56, s38, 9
    s_add_u32 s9, s9, s56
    s_add_u32 s56, s56, 22528
    v_lshlrev_b32 v253, 4, v14
    v_lshl_add_u32 v244, v15, 12, v253
    v_add_u32 v251, s56, v244
    s_lshl_b32 s57, s6, 3
    s_add_u32 s56, s56, s57
    v_add_u32 v252, s56, v253
    v_xor_b32 v240, s6, v15
    v_lshl_add_u32 v245, v240, 3, v253
    v_add_u32 v245, 8192, v245
    v_mul_u32_u24 v254, 33408, v15
    v_add_u32 v254, v254, v253
    v_mul_u32_u24 v240, 320, v15
    v_add_u32 v240, v240, v253
    v_add_u32 v240, 12288, v240
    v_cmp_eq_u32 vcc, 20, v14
    v_mov_b32 v241, 153728
    v_mov_b32 v242, 153744
    v_cndmask_b32 v241, v242, v241, vcc
    v_mul_u32_u24 v242, 192, v15
    v_cmp_lt_u32 vcc, 27, v14
    v_sub_u32 v242, 153792, v242
    s_nop 0
    v_cndmask_b32 v241, v241, v242, vcc
    v_cmp_gt_u32 vcc, 20, v14
    v_lshlrev_b32 v248, 4, v1
    s_mul_i32 s56, s38, 640
    v_cndmask_b32 v246, v241, v240, vcc
    v_cndmask_b32 v247, 0, -1, vcc
    s_add_u32 s56, s56, 153968
    v_lshl_add_u32 v249, v1, 2, s56
    v_and_b32 v250, 7, v1
    v_mul_u32_u24 v250, 644, v250
    v_add_u32 v250, 153968, v250
    s_mov_b32 s73, 0
    s_mov_b32 s74, 56
    s_cmp_ge_u32 s48, 20
    s_cselect_b32 s74, 56, s74
    s_cmp_ge_u32 s48, 30
    s_cselect_b32 s74, 7, s74
    s_mov_b32 s69, 22528
    v_mov_b32 v64, 0
    v_mov_b32 v65, 0
    v_mov_b32 v66, 0
    v_mov_b32 v67, 0
    v_mov_b32 v68, 0
    v_mov_b32 v69, 0
    v_mov_b32 v70, 0
    v_mov_b32 v71, 0
    v_mov_b32 v72, 0
    v_mov_b32 v73, 0
    v_mov_b32 v74, 0
    v_mov_b32 v75, 0
    v_mov_b32 v76, 0
    v_mov_b32 v77, 0
    v_mov_b32 v78, 0
    v_mov_b32 v79, 0
    v_mov_b32 v84, 0
    v_mov_b32 v85, 0
    v_mov_b32 v86, 0
    v_mov_b32 v104, 0
    v_mov_b32 v105, 0
    v_mov_b32 v106, 0
    v_mov_b32 v107, 0
    s_mul_i32 s56, s38, 3
    s_add_u32 s56, s56, 0
    s_min_u32 s56, s56, 21
    s_lshl_b32 s66, s56, 10
    s_lshr_b32 s57, s56, 2
    s_add_u32 s58, s7, s57
    s_cmp_eq_u32 s57, 2
    s_cselect_b32 s58, s8, s58
    s_add_u32 s58, s58, 80
    s_mul_i32 s58, s58, 33408
    s_and_b32 s59, s56, 3
    s_lshl_b32 s59, s59, 10
    s_add_u32 s58, s58, s59
    s_mul_i32 s59, s4, 81920
    s_add_u32 s59, s59, s66
    s_add_u32 s59, s59, 5361664
    s_cmp_lt_u32 s56, 12
    s_cselect_b32 s60, s58, s59
    s_cselect_b32 s63, 4, 10
    s_lshl_b32 s63, s63, 10
    s_mul_i32 s56, s38, 3
    s_add_u32 s56, s56, 1
    s_min_u32 s56, s56, 21
    s_lshl_b32 s67, s56, 10
    s_lshr_b32 s57, s56, 2
    s_add_u32 s58, s7, s57
    s_cmp_eq_u32 s57, 2
    s_cselect_b32 s58, s8, s58
    s_add_u32 s58, s58, 80
    s_mul_i32 s58, s58, 33408
    s_and_b32 s59, s56, 3
    s_lshl_b32 s59, s59, 10
    s_add_u32 s58, s58, s59
    s_mul_i32 s59, s4, 81920
    s_add_u32 s59, s59, s67
    s_add_u32 s59, s59, 5361664
    s_cmp_lt_u32 s56, 12
    s_cselect_b32 s61, s58, s59
    s_cselect_b32 s64, 4, 10
    s_lshl_b32 s64, s64, 10
    s_mul_i32 s56, s38, 3
    s_add_u32 s56, s56, 2
    s_min_u32 s56, s56, 21
    s_lshl_b32 s68, s56, 10
    s_lshr_b32 s57, s56, 2
    s_add_u32 s58, s7, s57
    s_cmp_eq_u32 s57, 2
    s_cselect_b32 s58, s8, s58
    s_add_u32 s58, s58, 80
    s_mul_i32 s58, s58, 33408
    s_and_b32 s59, s56, 3
    s_lshl_b32 s59, s59, 10
    s_add_u32 s58, s58, s59
    s_mul_i32 s59, s4, 81920
    s_add_u32 s59, s59, s68
    s_add_u32 s59, s59, 5361664
    s_cmp_lt_u32 s56, 12
    s_cselect_b32 s62, s58, s59
    s_cselect_b32 s65, 4, 10
    s_lshl_b32 s65, s65, 10
    s_lshl_b32 s56, s63, 1
    s_add_u32 s60, s60, s56
    s_lshl_b32 s56, s64, 1
    s_add_u32 s61, s61, s56
    s_lshl_b32 s56, s65, 1
    s_add_u32 s62, s62, s56
    s_min_u32 s56, s7, s8
    s_lshr_b32 s56, s56, 4
    s_add_u32 s57, s7, 1
    s_max_u32 s57, s57, s8
    s_lshr_b32 s57, s57, 4
    s_mul_i32 s58, s4, 20
    s_add_u32 s59, s58, 19
    s_lshr_b32 s58, s58, 7
    s_lshr_b32 s59, s59, 7
    v_bfe_u32 v2, v1, 4, 1
    v_cmp_eq_u32 vcc, 0, v2
    v_mov_b32 v6, s57
    v_mov_b32 v7, s56
    v_cndmask_b32 v6, v6, v7, vcc
    v_mov_b32 v7, s59
    v_mov_b32 v3, s58
    v_cndmask_b32 v7, v7, v3, vcc
    v_add_u32 v7, 5, v7
    v_cmp_gt_u32 vcc, 32, v1
    v_and_b32 v2, 15, v1
    v_lshlrev_b32 v2, 2, v2
    v_cndmask_b32 v7, v7, v6, vcc
    v_lshl_add_u32 v6, v6, 6, v2
    v_lshl_add_u32 v7, v7, 6, v2
    v_add_u32 v7, 320, v7
    v_mov_b32 v13, 153936
    s_waitcnt vmcnt(0)
    s_barrier
    s_cmp_lt_u32 s48, 20
    s_cbranch_scc1 L_U1
L_ATT:
L_WN:
    ds_read_b32 v2, v13 offset:4
    s_waitcnt lgkmcnt(0)
    v_cmp_ne_u32 vcc, 0, v2
    s_cbranch_vccnz L_WN1
    s_sleep 1
    s_branch L_WN
L_WN1:
    v_readfirstlane_b32 s55, v2
    s_lshl_b32 s96, s39, 10
    s_add_u32 s96, s96, 16154624
    v_mov_b32 v13, 154592
    s_cmp_lg_u32 s98, 0
    s_cbranch_scc1 L_WGO
    s_cmp_lt_u32 s48, 20
    s_cbranch_scc1 L_P1_OK
    s_and_b32 s56, s48, 15
    s_lshr_b32 s58, s39, 1
    s_cmp_eq_u32 s58, 1
    s_cselect_b32 s59, 32, 0
    s_add_u32 s56, s56, s59
    s_cmp_eq_u32 s58, 2
    v_readlane_b32 s57, v7, s56
    v_readlane_b32 s59, v6, s56
    s_nop 3
    s_cselect_b32 s57, s59, s57
    v_mov_b32 v2, s57
    s_mov_b32 s97, 32768
L_P1:
    buffer_load_dword v3, v2, s[12:15], s96 offen sc1
    s_waitcnt vmcnt(0)
    v_cmp_ne_u32 vcc, s55, v3
    s_cbranch_vccz L_P1_OK
    s_sleep 16
    s_sub_u32 s97, s97, 1
    s_cmp_lg_u32 s97, 0
    s_cbranch_scc1 L_P1
L_P1_OK:
    s_mov_b32 s97, 32768
L_PQ:
    buffer_load_dword v2, v6, s[12:15], s96 offen sc1
    buffer_load_dword v3, v7, s[12:15], s96 offen sc1
    s_waitcnt vmcnt(0)
    v_cmp_ne_u32 vcc, s55, v2
    v_cmp_ne_u32 s[10:11], s55, v3
    s_nop 0
    s_or_b64 vcc, vcc, s[10:11]
    s_cbranch_vccz L_PQ_OK
    s_sleep 8
    s_sub_u32 s97, s97, 1
    s_cmp_lg_u32 s97, 0
    s_cbranch_scc1 L_PQ
L_PQ_OK:
    v_mov_b32 v5, 1
    ds_write_b32 v13, v5
    s_branch L_GO
L_WGO:
    ds_read_b32 v5, v13
    s_waitcnt lgkmcnt(0)
    v_cmp_eq_u32 vcc, 0, v5
    s_cbranch_vccz L_GO
    s_sleep 1
    s_branch L_WGO
L_GO:
    s_lshl_b32 s96, s98, 10
    s_mul_i32 s56, s7, 33408
    s_add_u32 s56, s56, s96
    s_mul_i32 s57, s8, 33408
    s_add_u32 s57, s57, s96
    s_lshl_b32 s58, s5, 12
    s_add_u32 m0, s96, 131072
    s_add_u32 s59, s56, 2672640
    buffer_load_dwordx4 v248, s[12:15], s59 offen sc1 lds
    s_add_u32 m0, s96, 135168
    s_add_u32 s59, s56, 2706048
    buffer_load_dwordx4 v248, s[12:15], s59 offen sc1 lds
    s_add_u32 m0, s96, 139264
    s_add_u32 s59, s57, 2672640
    buffer_load_dwordx4 v248, s[12:15], s59 offen sc1 lds
    s_mul_i32 s59, s4, 81920
    s_add_u32 s59, s59, 5373952
    s_add_u32 s10, s96, 8192
    s_min_u32 s10, s10, 9216
    s_add_u32 m0, s96, 143360
    s_add_u32 s11, s96, 0
    s_add_u32 s11, s11, s59
    buffer_load_dwordx4 v248, s[12:15], s11 offen sc1 lds
    s_add_u32 m0, s96, 147456
    s_add_u32 s11, s96, 4096
    s_add_u32 s11, s11, s59
    buffer_load_dwordx4 v248, s[12:15], s11 offen sc1 lds
    s_add_u32 m0, s10, 143360
    s_add_u32 s11, s10, 0
    s_add_u32 s11, s11, s59
    buffer_load_dwordx4 v248, s[12:15], s11 offen sc1 lds
    s_mov_b32 s97, s59
    s_cmp_ge_u32 s48, 20
    s_cbranch_scc1 L_NB18
    s_waitcnt vmcnt(14)
    s_barrier
L_NB18:
    s_add_u32 m0, s96, 22528
    s_add_u32 s59, s56, 0
    s_add_u32 s59, s59, s58
    buffer_load_dwordx4 v248, s[12:15], s59 offen sc1 lds
    s_add_u32 m0, s96, 26624
    s_add_u32 s59, s56, 33408
    s_add_u32 s59, s59, s58
    buffer_load_dwordx4 v248, s[12:15], s59 offen sc1 lds
    s_add_u32 m0, s96, 30720
    s_add_u32 s59, s57, 0
    s_add_u32 s59, s59, s58
    buffer_load_dwordx4 v248, s[12:15], s59 offen sc1 lds
    s_add_u32 m0, s96, 0
    s_add_u32 s59, s56, 2676736
    buffer_load_dwordx4 v248, s[12:15], s59 offen sc1 lds
    s_add_u32 m0, s96, 4096
    s_add_u32 s59, s56, 2710144
    buffer_load_dwordx4 v248, s[12:15], s59 offen sc1 lds
    s_add_u32 m0, s96, 8192
    s_add_u32 s59, s57, 2676736
    buffer_load_dwordx4 v248, s[12:15], s59 offen sc1 lds
    s_mov_b32 s59, s97
    s_add_u32 m0, s96, 12288
    s_add_u32 s11, s96, 10240
    s_add_u32 s11, s11, s59
    buffer_load_dwordx4 v248, s[12:15], s11 offen sc1 lds
    s_add_u32 m0, s96, 16384
    s_add_u32 s11, s96, 14336
    s_add_u32 s11, s11, s59
    buffer_load_dwordx4 v248, s[12:15], s11 offen sc1 lds
    s_add_u32 m0, s10, 12288
    s_add_u32 s11, s10, 10240
    s_add_u32 s11, s11, s59
    buffer_load_dwordx4 v248, s[12:15], s11 offen sc1 lds
    s_cmp_ge_u32 s48, 20
    s_cbranch_scc1 L_NB19
    s_waitcnt vmcnt(15)
    s_barrier
L_NB19:
    s_cmp_ge_u32 s48, 20
    s_cbranch_scc1 L_NWS
    v_bfe_u32 v224, v1, 4, 1
    v_bfe_u32 v225, v1, 1, 1
    v_lshl_add_u32 v224, v224, 1, v225
    v_bfe_u32 v225, v1, 3, 1
    v_lshlrev_b32 v225, 2, v225
    v_xor_b32 v224, v224, v225
    v_bfe_u32 v225, v1, 2, 2
    v_lshl_add_u32 v225, v15, 3, v225
    v_lshlrev_b32 v225, 7, v225
    v_lshl_add_u32 v224, v224, 4, v225
    v_and_b32 v225, 1, v1
    v_lshl_add_u32 v224, v225, 3, v224
    v_add_u32 v224, 45056, v224
    v_xor_b32 v225, 64, v224
    s_and_b32 s56, s38, 3
    s_lshl_b32 s56, s56, 13
    s_lshr_b32 s57, s38, 2
    s_mul_i32 s58, s57, 126976
    s_add_u32 s58, s58, s56
    v_lshl_add_u32 v226, v14, 2, s58
    v_lshl_add_u32 v226, v15, 10, v226
    s_lshl_b32 s57, s57, 12
    s_add_u32 s56, s56, s57
    v_add_u32 v228, s56, v248
    v_add_u32 v229, 126976, v228
    v_lshrrev_b32 v227, 4, v1
    v_mul_u32_u24 v227, 5120, v227
    v_and_b32 v242, 0xf0, v248
    v_add_u32 v227, v227, v242
    v_lshrrev_b32 v230, 3, v1
    v_and_b32 v231, 7, v1
    v_bfe_u32 v2, v1, 4, 1
    v_lshlrev_b32 v2, 2, v2
    v_xor_b32 v231, v231, v2
    v_lshlrev_b32 v231, 4, v231
    v_mul_u32_u24 v230, 1280, v230
    v_add_u32 v230, v230, v231
    v_mul_u32_u24 v231, 20480, v15
    v_add_u32 v231, v231, v230
    s_mul_i32 s99, s98, 204800
    s_lshl_b32 s58, s52, 7
    s_add_u32 s99, s99, s58
    s_mul_i32 s101, s98, 20480
    s_add_u32 s101, s101, 45056
    s_branch L_NCS
L_NWS:
    v_lshrrev_b32 v2, 4, v1
    v_and_b32 v3, 7, v1
    v_xor_b32 v3, v3, v2
    v_lshlrev_b32 v3, 4, v3
    v_lshrrev_b32 v2, 3, v1
    v_mul_u32_u24 v2, 1280, v2
    v_add_u32 v234, v2, v3
    v_xor_b32 v235, 64, v234
    v_lshlrev_b32 v242, 7, v1
    s_mul_i32 s56, s51, 327680
    s_add_u32 s56, s56, 10682368
    s_mul_i32 s57, s52, 163840
    s_mul_i32 s99, s98, 81920
    s_add_u32 s99, s99, s56
    s_mul_i32 s100, s98, 40960
    s_add_u32 s100, s100, s57
    s_mov_b32 s43, s100
    s_mul_i32 s101, s98, 4352
    s_lshl_b32 s3, s98, 12
L_NCS:
    s_waitcnt vmcnt(6)
    s_barrier
    s_branch ATT_START
PK_COMPUTE:
    s_load_dwordx2 s[12:13], s[0:1], 112
    s_load_dwordx2 s[16:17], s[0:1], 24
    s_load_dwordx2 s[28:29], s[0:1], 16
    s_load_dwordx2 s[32:33], s[0:1], 96
    s_load_dwordx2 s[36:37], s[0:1], 104
    s_load_dwordx4 s[40:43], s[0:1], 32
    s_load_dwordx4 s[44:47], s[0:1], 80
    s_sub_u32 s56, s48, 20
    s_cmp_lt_u32 s48, 20
    s_cselect_b32 s56, s48, s56
    s_cselect_b32 s57, 48, 64
    s_load_dwordx2 s[20:21], s[0:1], s57
    s_cbranch_scc1 C_UMAP
    s_and_b32 s51, s56, 1
    s_lshl_b32 s58, s39, 1
    s_add_u32 s51, s51, s58
    s_lshr_b32 s52, s56, 1
    s_branch C_MAPPED
C_UMAP:
    s_and_b32 s51, s56, 3
    s_lshr_b32 s58, s39, 1
    s_lshl_b32 s58, s58, 2
    s_add_u32 s51, s51, s58
    s_lshr_b32 s52, s56, 2
    s_and_b32 s58, s39, 1
    s_mul_i32 s58, s58, 5
    s_add_u32 s52, s52, s58
C_MAPPED:
    s_add_u32 s57, s57, 8
    s_load_dwordx2 s[24:25], s[0:1], s57
    v_and_b32 v14, 31, v1
    v_lshrrev_b32 v15, 5, v1
    s_getpc_b64 s[92:93]
C_PC:
    s_sub_u32 s92, s92, C_PC-PK_BEGIN
    s_subb_u32 s93, s93, 0
    s_mov_b32 s14, 16187392
    s_mov_b32 s15, 0x00020000
    s_mov_b32 s18, 2621440
    s_mov_b32 s19, 0x00020000
    s_mov_b32 s30, 819200
    s_mov_b32 s31, 0x00020000
    s_mov_b32 s34, 10485760
    s_mov_b32 s35, 0x00020000
    s_mov_b32 s22, 819200
    s_mov_b32 s23, 0x00020000
    s_mov_b32 s26, 819200
    s_mov_b32 s27, 0x00020000
    v_mov_b32 v6, 0
    v_mov_b32 v7, 0
    v_mov_b32 v120, 0
    v_mov_b32 v121, 0
    v_mov_b32 v122, 0
    v_mov_b32 v242, 0
    v_mov_b32 v227, 0
    v_mov_b32 v230, 0
    v_mov_b32 v231, 0
    v_mov_b32 v234, 0
    v_mov_b32 v235, 0
    v_mov_b32 v240, 0
    v_mov_b32 v241, 0
    v_mov_b32 v248, 0
    v_mov_b32 v253, 0
    v_mov_b32 v254, 0
    s_and_b32 s98, s38, 1
    s_lshr_b32 s99, s38, 1
    v_bfe_u32 v2, v1, 1, 3
    v_xor_b32 v2, v2, v15
    v_lshlrev_b32 v2, 4, v2
    v_lshl_add_u32 v13, v14, 7, v2
    s_lshl_b32 s56, s98, 13
    v_add_u32 v2, s56, v13
    v_xor_b32 v3, 32, v2
    v_xor_b32 v4, 64, v2
    v_xor_b32 v5, 96, v2
    v_bfe_u32 v8, v1, 2, 2
    v_bfe_u32 v9, v1, 4, 1
    v_bfe_u32 v10, v1, 1, 1
    v_lshl_add_u32 v9, v9, 1, v10
    s_lshl_b32 s56, s99, 3
    v_add_u32 v9, s56, v9
    v_lshlrev_b32 v10, 2, v8
    v_xor_b32 v9, v9, v10
    v_lshl_add_u32 v8, v15, 3, v8
    v_lshlrev_b32 v8, 8, v8
    v_lshl_add_u32 v8, v9, 4, v8
    v_and_b32 v10, 1, v1
    v_lshl_add_u32 v6, v10, 3, v8
    v_xor_b32 v7, 64, v6
    s_lshl_b32 s56, s99, 13
    s_add_u32 s56, s56, 16384
    v_add_u32 v52, s56, v13
    s_lshl_b32 s56, s52, 6
    s_lshl_b32 s57, s99, 5
    s_add_u32 s100, s56, s57
    v_add_u32 v8, s100, v14
    v_lshlrev_b32 v8, 1, v8
    v_mul_u32_u24 v254, 33408, v15
    v_lshl_add_u32 v254, v14, 4, v254
    s_lshl_b32 s58, s50, 6
    s_lshl_b32 s57, s49, 2
    s_add_u32 s58, s58, s57
    s_add_u32 s58, s58, 16154624
    s_cmp_ge_u32 s48, 20
    s_waitcnt lgkmcnt(0)
    s_cbranch_scc1 C_NOPL
    global_load_ushort v209, v8, s[40:41]
    global_load_ushort v210, v8, s[42:43]
    global_load_ushort v211, v8, s[44:45]
C_NOPL:
    s_add_u32 s42, s12, s58
    s_addc_u32 s43, s13, 0
    s_mov_b32 s54, 0
    s_cmp_eq_u32 s50, 15
    s_cbranch_scc1 C_NOQ
    v_mov_b32 v64, 0
    v_mov_b32 v65, 0
    v_mov_b32 v66, 0
    v_mov_b32 v67, 0
    v_mov_b32 v68, 0
    v_mov_b32 v69, 0
    v_mov_b32 v70, 0
    v_mov_b32 v71, 0
    v_mov_b32 v72, 0
    v_mov_b32 v73, 0
    v_mov_b32 v74, 0
    v_mov_b32 v75, 0
    v_mov_b32 v76, 0
    v_mov_b32 v77, 0
    v_mov_b32 v78, 0
    v_mov_b32 v79, 0
    v_mov_b32 v80, 0
    v_mov_b32 v81, 0
    v_mov_b32 v82, 0
    v_mov_b32 v83, 0
    v_mov_b32 v84, 0
    v_mov_b32 v85, 0
    v_mov_b32 v86, 0
    v_mov_b32 v87, 0
    v_mov_b32 v88, 0
    v_mov_b32 v89, 0
    v_mov_b32 v90, 0
    v_mov_b32 v91, 0
    v_mov_b32 v92, 0
    v_mov_b32 v93, 0
    v_mov_b32 v94, 0
    v_mov_b32 v95, 0
    v_mov_b32 v96, 0
    v_mov_b32 v97, 0
    v_mov_b32 v98, 0
    v_mov_b32 v99, 0
    v_mov_b32 v100, 0
    v_mov_b32 v101, 0
    v_mov_b32 v102, 0
    v_mov_b32 v103, 0
    v_mov_b32 v104, 0
    v_mov_b32 v105, 0
    v_mov_b32 v106, 0
    v_mov_b32 v107, 0
    v_mov_b32 v108, 0
    v_mov_b32 v109, 0
    v_mov_b32 v110, 0
    v_mov_b32 v111, 0
    v_mov_b32 v112, 0
    v_mov_b32 v113, 0
    v_mov_b32 v114, 0
    v_mov_b32 v115, 0
    v_mov_b32 v116, 0
    v_mov_b32 v117, 0
    v_mov_b32 v118, 0
    v_mov_b32 v119, 0
    v_mov_b32 v120, 0
    v_mov_b32 v121, 0
    v_mov_b32 v122, 0
    v_mov_b32 v123, 0
    v_mov_b32 v124, 0
    v_mov_b32 v125, 0
    v_mov_b32 v126, 0
    v_mov_b32 v127, 0
    v_mov_b32 v32, 0
    v_mov_b32 v33, 0
    v_mov_b32 v34, 0
    v_mov_b32 v35, 0
    v_mov_b32 v36, 0
    v_mov_b32 v37, 0
    v_mov_b32 v38, 0
    v_mov_b32 v39, 0
    v_mov_b32 v40, 0
    v_mov_b32 v41, 0
    v_mov_b32 v42, 0
    v_mov_b32 v43, 0
    v_mov_b32 v44, 0
    v_mov_b32 v45, 0
    v_mov_b32 v46, 0
    v_mov_b32 v47, 0
    v_mov_b32 v8, v2
    v_mov_b32 v9, v3
    v_mov_b32 v10, v4
    v_mov_b32 v11, v5
    v_mov_b32 v12, v6
    v_mov_b32 v13, v7
    s_cmp_ge_u32 s50, 10
    s_cbranch_scc1 C_VLOOP_PRE
    s_lshl_b32 s58, s50, 4
    s_lshl_b32 s56, s99, 3
    s_add_u32 s58, s58, s56
    s_mul_i32 s58, s58, 33408
    s_lshl_b32 s56, s49, 11
    s_add_u32 s58, s58, s56
    s_lshl_b32 s56, s98, 10
    s_add_u32 s58, s58, s56
    s_mov_b32 s53, 10
C_QKLOOP:
    s_barrier
    v_mfma_f32_32x32x16_bf16 v[64:79], v[40:43], v[32:35], v[64:79]
    ds_read_b128 v[16:19], v8 offset:0
    ds_read_b64_tr_b16 v[24:25], v12 offset:16384
    ds_read_b64_tr_b16 v[26:27], v12 offset:17408
    v_mfma_f32_32x32x16_bf16 v[96:111], v[40:43], v[36:39], v[96:111]
    ds_read_b128 v[20:23], v8 offset:4096
    ds_read_b64_tr_b16 v[28:29], v13 offset:16384
    ds_read_b64_tr_b16 v[30:31], v13 offset:17408
    v_mfma_f32_32x32x16_bf16 v[80:95], v[44:47], v[32:35], v[80:95]
    s_add_u32 s54, s54, 32768
    s_cmp_eq_u32 s54, 131072
    s_cselect_b32 s54, 0, s54
    v_add_u32 v8, s54, v2
    v_mfma_f32_32x32x16_bf16 v[112:127], v[44:47], v[36:39], v[112:127]
    s_waitcnt lgkmcnt(0)
    v_mfma_f32_32x32x16_bf16 v[64:79], v[24:27], v[16:19], v[64:79]
    ds_read_b128 v[32:35], v9 offset:0
    ds_read_b64_tr_b16 v[40:41], v12 offset:20480
    ds_read_b64_tr_b16 v[42:43], v12 offset:21504
    v_mfma_f32_32x32x16_bf16 v[96:111], v[24:27], v[20:23], v[96:111]
    ds_read_b128 v[36:39], v9 offset:4096
    ds_read_b64_tr_b16 v[44:45], v13 offset:20480
    ds_read_b64_tr_b16 v[46:47], v13 offset:21504
    v_mfma_f32_32x32x16_bf16 v[80:95], v[28:31], v[16:19], v[80:95]
    v_add_u32 v9, s54, v3
    v_mfma_f32_32x32x16_bf16 v[112:127], v[28:31], v[20:23], v[112:127]
    s_waitcnt lgkmcnt(0)
    v_mfma_f32_32x32x16_bf16 v[64:79], v[40:43], v[32:35], v[64:79]
    ds_read_b128 v[16:19], v10 offset:0
    ds_read_b64_tr_b16 v[24:25], v12 offset:24576
    ds_read_b64_tr_b16 v[26:27], v12 offset:25600
    v_mfma_f32_32x32x16_bf16 v[96:111], v[40:43], v[36:39], v[96:111]
    ds_read_b128 v[20:23], v10 offset:4096
    ds_read_b64_tr_b16 v[28:29], v13 offset:24576
    ds_read_b64_tr_b16 v[30:31], v13 offset:25600
    v_mfma_f32_32x32x16_bf16 v[80:95], v[44:47], v[32:35], v[80:95]
    v_add_u32 v10, s54, v4
    v_mfma_f32_32x32x16_bf16 v[112:127], v[44:47], v[36:39], v[112:127]
    s_waitcnt lgkmcnt(0)
    v_mfma_f32_32x32x16_bf16 v[64:79], v[24:27], v[16:19], v[64:79]
    ds_read_b128 v[32:35], v11 offset:0
    ds_read_b64_tr_b16 v[40:41], v12 offset:28672
    ds_read_b64_tr_b16 v[42:43], v12 offset:29696
    v_mfma_f32_32x32x16_bf16 v[96:111], v[24:27], v[20:23], v[96:111]
    ds_read_b128 v[36:39], v11 offset:4096
    ds_read_b64_tr_b16 v[44:45], v13 offset:28672
    ds_read_b64_tr_b16 v[46:47], v13 offset:29696
    v_mfma_f32_32x32x16_bf16 v[80:95], v[28:31], v[16:19], v[80:95]
    v_add_u32 v11, s54, v5
    v_add_u32 v12, s54, v6
    v_add_u32 v13, s54, v7
    s_sub_u32 s53, s53, 1
    s_cmp_lg_u32 s53, 0
    v_mfma_f32_32x32x16_bf16 v[112:127], v[28:31], v[20:23], v[112:127]
    s_waitcnt lgkmcnt(0)
    s_cbranch_scc1 C_QKLOOP
    v_mfma_f32_32x32x16_bf16 v[64:79], v[40:43], v[32:35], v[64:79]
    v_mfma_f32_32x32x16_bf16 v[96:111], v[40:43], v[36:39], v[96:111]
    v_mfma_f32_32x32x16_bf16 v[80:95], v[44:47], v[32:35], v[80:95]
    v_mfma_f32_32x32x16_bf16 v[112:127], v[44:47], v[36:39], v[112:127]
    s_cmp_lt_u32 s48, 20
    s_cbranch_scc1 C_NBQ0
    s_barrier
C_NBQ0:
    v_mov_b32 v48, 0
    global_load_dword v49, v48, s[36:37] sc1
    s_nop 7
    s_nop 1
    v_cvt_pk_bf16_f32 v16, v64, v65
    v_cvt_pk_bf16_f32 v17, v66, v67
    v_cvt_pk_bf16_f32 v18, v68, v69
    v_cvt_pk_bf16_f32 v19, v70, v71
    v_cvt_pk_bf16_f32 v20, v72, v73
    v_cvt_pk_bf16_f32 v21, v74, v75
    v_cvt_pk_bf16_f32 v22, v76, v77
    v_cvt_pk_bf16_f32 v23, v78, v79
    s_add_u32 s56, s58, 0
    s_add_u32 s57, s58, 66816
    v_permlane32_swap_b32 v16, v18
    v_permlane32_swap_b32 v17, v19
    v_permlane32_swap_b32 v20, v22
    v_permlane32_swap_b32 v21, v23
    buffer_store_dwordx4 v[16:19], v254, s[12:15], s56 offen offset:0 sc1
    buffer_store_dwordx4 v[20:23], v254, s[12:15], s57 offen offset:0 sc1
    v_cvt_pk_bf16_f32 v24, v96, v97
    v_cvt_pk_bf16_f32 v25, v98, v99
    v_cvt_pk_bf16_f32 v26, v100, v101
    v_cvt_pk_bf16_f32 v27, v102, v103
    v_cvt_pk_bf16_f32 v28, v104, v105
    v_cvt_pk_bf16_f32 v29, v106, v107
    v_cvt_pk_bf16_f32 v30, v108, v109
    v_cvt_pk_bf16_f32 v31, v110, v111
    s_add_u32 s56, s58, 0
    s_add_u32 s57, s58, 66816
    v_permlane32_swap_b32 v24, v26
    v_permlane32_swap_b32 v25, v27
    v_permlane32_swap_b32 v28, v30
    v_permlane32_swap_b32 v29, v31
    buffer_store_dwordx4 v[24:27], v254, s[12:15], s56 offen offset:512 sc1
    buffer_store_dwordx4 v[28:31], v254, s[12:15], s57 offen offset:512 sc1
    v_cvt_pk_bf16_f32 v56, v80, v81
    v_cvt_pk_bf16_f32 v57, v82, v83
    v_cvt_pk_bf16_f32 v58, v84, v85
    v_cvt_pk_bf16_f32 v59, v86, v87
    v_cvt_pk_bf16_f32 v60, v88, v89
    v_cvt_pk_bf16_f32 v61, v90, v91
    v_cvt_pk_bf16_f32 v62, v92, v93
    v_cvt_pk_bf16_f32 v63, v94, v95
    s_add_u32 s56, s58, 133632
    s_add_u32 s57, s58, 200448
    v_permlane32_swap_b32 v56, v58
    v_permlane32_swap_b32 v57, v59
    v_permlane32_swap_b32 v60, v62
    v_permlane32_swap_b32 v61, v63
    buffer_store_dwordx4 v[56:59], v254, s[12:15], s56 offen offset:0 sc1
    buffer_store_dwordx4 v[60:63], v254, s[12:15], s57 offen offset:0 sc1
    v_cvt_pk_bf16_f32 v16, v112, v113
    v_cvt_pk_bf16_f32 v17, v114, v115
    v_cvt_pk_bf16_f32 v18, v116, v117
    v_cvt_pk_bf16_f32 v19, v118, v119
    v_cvt_pk_bf16_f32 v20, v120, v121
    v_cvt_pk_bf16_f32 v21, v122, v123
    v_cvt_pk_bf16_f32 v22, v124, v125
    v_cvt_pk_bf16_f32 v23, v126, v127
    s_add_u32 s56, s58, 133632
    s_add_u32 s57, s58, 200448
    v_permlane32_swap_b32 v16, v18
    v_permlane32_swap_b32 v17, v19
    v_permlane32_swap_b32 v20, v22
    v_permlane32_swap_b32 v21, v23
    buffer_store_dwordx4 v[16:19], v254, s[12:15], s56 offen offset:512 sc1
    buffer_store_dwordx4 v[20:23], v254, s[12:15], s57 offen offset:512 sc1
    s_branch C_QDONE
C_VLOOP_PRE:
    s_sub_u32 s56, s50, 10
    s_lshl_b32 s56, s56, 7
    s_lshl_b32 s57, s99, 6
    s_add_u32 s56, s56, s57
    v_add_u32 v50, s56, v14
    v_add_u32 v51, 32, v50
    v_mul_u32_u24 v16, 3277, v50
    v_mul_u32_u24 v17, 3277, v51
    v_lshrrev_b32 v16, 16, v16
    v_lshrrev_b32 v17, 16, v17
    v_mul_u32_u24 v18, 20, v16
    v_mul_u32_u24 v19, 20, v17
    v_sub_u32 v50, v50, v18
    v_sub_u32 v51, v51, v19
    v_mul_u32_u24 v16, 81920, v16
    v_mul_u32_u24 v17, 81920, v17
    v_lshl_add_u32 v50, v50, 4, v16
    v_lshl_add_u32 v51, v51, 4, v17
    v_mul_u32_u24 v16, 320, v15
    v_add_u32 v50, v50, v16
    v_add_u32 v51, v51, v16
    s_lshl_b32 s58, s49, 2
    s_lshl_b32 s56, s98, 1
    s_add_u32 s58, s58, s56
    s_mul_i32 s58, s58, 1280
    s_add_u32 s58, s58, 5373952
    s_mov_b32 s53, 10
C_VLOOP:
    s_barrier
    v_mfma_f32_32x32x16_bf16 v[64:79], v[32:35], v[40:43], v[64:79]
    ds_read_b128 v[16:19], v8 offset:0
    ds_read_b64_tr_b16 v[24:25], v12 offset:16384
    ds_read_b64_tr_b16 v[26:27], v12 offset:17408
    v_mfma_f32_32x32x16_bf16 v[96:111], v[36:39], v[40:43], v[96:111]
    ds_read_b128 v[20:23], v8 offset:4096
    ds_read_b64_tr_b16 v[28:29], v13 offset:16384
    ds_read_b64_tr_b16 v[30:31], v13 offset:17408
    v_mfma_f32_32x32x16_bf16 v[80:95], v[32:35], v[44:47], v[80:95]
    s_add_u32 s54, s54, 32768
    s_cmp_eq_u32 s54, 131072
    s_cselect_b32 s54, 0, s54
    v_add_u32 v8, s54, v2
    v_mfma_f32_32x32x16_bf16 v[112:127], v[36:39], v[44:47], v[112:127]
    s_waitcnt lgkmcnt(0)
    v_mfma_f32_32x32x16_bf16 v[64:79], v[16:19], v[24:27], v[64:79]
    ds_read_b128 v[32:35], v9 offset:0
    ds_read_b64_tr_b16 v[40:41], v12 offset:20480
    ds_read_b64_tr_b16 v[42:43], v12 offset:21504
    v_mfma_f32_32x32x16_bf16 v[96:111], v[20:23], v[24:27], v[96:111]
    ds_read_b128 v[36:39], v9 offset:4096
    ds_read_b64_tr_b16 v[44:45], v13 offset:20480
    ds_read_b64_tr_b16 v[46:47], v13 offset:21504
    v_mfma_f32_32x32x16_bf16 v[80:95], v[16:19], v[28:31], v[80:95]
    v_add_u32 v9, s54, v3
    v_mfma_f32_32x32x16_bf16 v[112:127], v[20:23], v[28:31], v[112:127]
    s_waitcnt lgkmcnt(0)
    v_mfma_f32_32x32x16_bf16 v[64:79], v[32:35], v[40:43], v[64:79]
    ds_read_b128 v[16:19], v10 offset:0
    ds_read_b64_tr_b16 v[24:25], v12 offset:24576
    ds_read_b64_tr_b16 v[26:27], v12 offset:25600
    v_mfma_f32_32x32x16_bf16 v[96:111], v[36:39], v[40:43], v[96:111]
    ds_read_b128 v[20:23], v10 offset:4096
    ds_read_b64_tr_b16 v[28:29], v13 offset:24576
    ds_read_b64_tr_b16 v[30:31], v13 offset:25600
    v_mfma_f32_32x32x16_bf16 v[80:95], v[32:35], v[44:47], v[80:95]
    v_add_u32 v10, s54, v4
    v_mfma_f32_32x32x16_bf16 v[112:127], v[36:39], v[44:47], v[112:127]
    s_waitcnt lgkmcnt(0)
    v_mfma_f32_32x32x16_bf16 v[64:79], v[16:19], v[24:27], v[64:79]
    ds_read_b128 v[32:35], v11 offset:0
    ds_read_b64_tr_b16 v[40:41], v12 offset:28672
    ds_read_b64_tr_b16 v[42:43], v12 offset:29696
    v_mfma_f32_32x32x16_bf16 v[96:111], v[20:23], v[24:27], v[96:111]
    ds_read_b128 v[36:39], v11 offset:4096
    ds_read_b64_tr_b16 v[44:45], v13 offset:28672
    ds_read_b64_tr_b16 v[46:47], v13 offset:29696
    v_mfma_f32_32x32x16_bf16 v[80:95], v[16:19], v[28:31], v[80:95]
    v_add_u32 v11, s54, v5
    v_add_u32 v12, s54, v6
    v_add_u32 v13, s54, v7
    s_sub_u32 s53, s53, 1
    s_cmp_lg_u32 s53, 0
    v_mfma_f32_32x32x16_bf16 v[112:127], v[20:23], v[28:31], v[112:127]
    s_waitcnt lgkmcnt(0)
    s_cbranch_scc1 C_VLOOP
    v_mfma_f32_32x32x16_bf16 v[64:79], v[32:35], v[40:43], v[64:79]
    v_mfma_f32_32x32x16_bf16 v[96:111], v[36:39], v[40:43], v[96:111]
    v_mfma_f32_32x32x16_bf16 v[80:95], v[32:35], v[44:47], v[80:95]
    v_mfma_f32_32x32x16_bf16 v[112:127], v[36:39], v[44:47], v[112:127]
    s_cmp_lt_u32 s48, 20
    s_cbranch_scc1 C_NBQ1
    s_barrier
C_NBQ1:
    v_mov_b32 v48, 0
    global_load_dword v49, v48, s[36:37] sc1
    s_nop 7
    s_nop 1
    v_cvt_pk_bf16_f32 v16, v64, v65
    v_cvt_pk_bf16_f32 v17, v66, v67
    v_cvt_pk_bf16_f32 v18, v68, v69
    v_cvt_pk_bf16_f32 v19, v70, v71
    v_cvt_pk_bf16_f32 v20, v72, v73
    v_cvt_pk_bf16_f32 v21, v74, v75
    v_cvt_pk_bf16_f32 v22, v76, v77
    v_cvt_pk_bf16_f32 v23, v78, v79
    buffer_store_dwordx4 v[16:19], v50, s[12:15], s58 offen offset:0 sc1
    buffer_store_dwordx4 v[20:23], v50, s[12:15], s58 offen offset:640 sc1
    v_cvt_pk_bf16_f32 v24, v96, v97
    v_cvt_pk_bf16_f32 v25, v98, v99
    v_cvt_pk_bf16_f32 v26, v100, v101
    v_cvt_pk_bf16_f32 v27, v102, v103
    v_cvt_pk_bf16_f32 v28, v104, v105
    v_cvt_pk_bf16_f32 v29, v106, v107
    v_cvt_pk_bf16_f32 v30, v108, v109
    v_cvt_pk_bf16_f32 v31, v110, v111
    buffer_store_dwordx4 v[24:27], v50, s[12:15], s58 offen offset:1280 sc1
    buffer_store_dwordx4 v[28:31], v50, s[12:15], s58 offen offset:1920 sc1
    v_cvt_pk_bf16_f32 v56, v80, v81
    v_cvt_pk_bf16_f32 v57, v82, v83
    v_cvt_pk_bf16_f32 v58, v84, v85
    v_cvt_pk_bf16_f32 v59, v86, v87
    v_cvt_pk_bf16_f32 v60, v88, v89
    v_cvt_pk_bf16_f32 v61, v90, v91
    v_cvt_pk_bf16_f32 v62, v92, v93
    v_cvt_pk_bf16_f32 v63, v94, v95
    buffer_store_dwordx4 v[56:59], v51, s[12:15], s58 offen offset:0 sc1
    buffer_store_dwordx4 v[60:63], v51, s[12:15], s58 offen offset:640 sc1
    v_cvt_pk_bf16_f32 v16, v112, v113
    v_cvt_pk_bf16_f32 v17, v114, v115
    v_cvt_pk_bf16_f32 v18, v116, v117
    v_cvt_pk_bf16_f32 v19, v118, v119
    v_cvt_pk_bf16_f32 v20, v120, v121
    v_cvt_pk_bf16_f32 v21, v122, v123
    v_cvt_pk_bf16_f32 v22, v124, v125
    v_cvt_pk_bf16_f32 v23, v126, v127
    buffer_store_dwordx4 v[16:19], v51, s[12:15], s58 offen offset:1280 sc1
    buffer_store_dwordx4 v[20:23], v51, s[12:15], s58 offen offset:1920 sc1
C_QDONE:
    s_cmp_ge_u32 s48, 20
    s_cbranch_scc1 C_NBS
    s_barrier
    v_mov_b32 v32, 0
    v_mov_b32 v33, 0
    v_mov_b32 v34, 0
    v_mov_b32 v35, 0
    v_mov_b32 v36, 0
    v_mov_b32 v37, 0
    v_mov_b32 v38, 0
    v_mov_b32 v39, 0
    v_mov_b32 v40, 0
    v_mov_b32 v41, 0
    v_mov_b32 v42, 0
    v_mov_b32 v43, 0
    v_mov_b32 v44, 0
    v_mov_b32 v45, 0
    v_mov_b32 v46, 0
    v_mov_b32 v47, 0
    v_mov_b32 v128, 0
    v_mov_b32 v129, 0
    v_mov_b32 v130, 0
    v_mov_b32 v131, 0
    v_mov_b32 v132, 0
    v_mov_b32 v133, 0
    v_mov_b32 v134, 0
    v_mov_b32 v135, 0
    v_mov_b32 v136, 0
    v_mov_b32 v137, 0
    v_mov_b32 v138, 0
    v_mov_b32 v139, 0
    v_mov_b32 v140, 0
    v_mov_b32 v141, 0
    v_mov_b32 v142, 0
    v_mov_b32 v143, 0
    v_mov_b32 v144, 0
    v_mov_b32 v145, 0
    v_mov_b32 v146, 0
    v_mov_b32 v147, 0
    v_mov_b32 v148, 0
    v_mov_b32 v149, 0
    v_mov_b32 v150, 0
    v_mov_b32 v151, 0
    v_mov_b32 v152, 0
    v_mov_b32 v153, 0
    v_mov_b32 v154, 0
    v_mov_b32 v155, 0
    v_mov_b32 v156, 0
    v_mov_b32 v157, 0
    v_mov_b32 v158, 0
    v_mov_b32 v159, 0
    v_mov_b32 v160, 0
    v_mov_b32 v161, 0
    v_mov_b32 v162, 0
    v_mov_b32 v163, 0
    v_mov_b32 v164, 0
    v_mov_b32 v165, 0
    v_mov_b32 v166, 0
    v_mov_b32 v167, 0
    v_mov_b32 v168, 0
    v_mov_b32 v169, 0
    v_mov_b32 v170, 0
    v_mov_b32 v171, 0
    v_mov_b32 v172, 0
    v_mov_b32 v173, 0
    v_mov_b32 v174, 0
    v_mov_b32 v175, 0
    v_mov_b32 v176, 0
    v_mov_b32 v177, 0
    v_mov_b32 v178, 0
    v_mov_b32 v179, 0
    v_mov_b32 v180, 0
    v_mov_b32 v181, 0
    v_mov_b32 v182, 0
    v_mov_b32 v183, 0
    v_mov_b32 v184, 0
    v_mov_b32 v185, 0
    v_mov_b32 v186, 0
    v_mov_b32 v187, 0
    v_mov_b32 v188, 0
    v_mov_b32 v189, 0
    v_mov_b32 v190, 0
    v_mov_b32 v191, 0
    v_xor_b32 v53, 32, v52
    v_xor_b32 v54, 64, v52
    v_xor_b32 v55, 96, v52
    v_add_u32 v56, s54, v52
    v_add_u32 v57, s54, v53
    v_add_u32 v58, s54, v54
    v_add_u32 v59, s54, v55
C_NBS:
C_SETUP:
    s_lshl_b32 s4, s39, 2
    s_and_b32 s56, s48, 3
    s_add_u32 s4, s4, s56
    s_lshr_b32 s5, s48, 2
    s_lshr_b32 s56, s4, 1
    s_mul_i32 s56, s56, 5
    s_and_b32 s6, s4, 1
    s_mul_i32 s7, s6, 3
    s_add_u32 s7, s7, s56
    s_add_u32 s8, s56, 2
    s_lshl_b32 s9, s5, 12
    s_lshl_b32 s56, s38, 9
    s_add_u32 s9, s9, s56
    s_add_u32 s56, s56, 22528
    v_lshlrev_b32 v253, 4, v14
    v_lshl_add_u32 v244, v15, 12, v253
    v_add_u32 v251, s56, v244
    s_lshl_b32 s57, s6, 3
    s_add_u32 s56, s56, s57
    v_add_u32 v252, s56, v253
    v_xor_b32 v240, s6, v15
    v_lshl_add_u32 v245, v240, 3, v253
    v_add_u32 v245, 8192, v245
    v_mul_u32_u24 v254, 33408, v15
    v_add_u32 v254, v254, v253
    v_mul_u32_u24 v240, 320, v15
    v_add_u32 v240, v240, v253
    v_add_u32 v240, 12288, v240
    v_cmp_eq_u32 vcc, 20, v14
    v_mov_b32 v241, 153728
    v_mov_b32 v242, 153744
    v_cndmask_b32 v241, v242, v241, vcc
    v_mul_u32_u24 v242, 192, v15
    v_cmp_lt_u32 vcc, 27, v14
    v_sub_u32 v242, 153792, v242
    s_nop 0
    v_cndmask_b32 v241, v241, v242, vcc
    v_cmp_gt_u32 vcc, 20, v14
    v_lshlrev_b32 v248, 4, v1
    s_mul_i32 s56, s38, 640
    v_cndmask_b32 v246, v241, v240, vcc
    v_cndmask_b32 v247, 0, -1, vcc
    s_add_u32 s56, s56, 153968
    v_lshl_add_u32 v249, v1, 2, s56
    v_and_b32 v250, 7, v1
    v_mul_u32_u24 v250, 644, v250
    v_add_u32 v250, 153968, v250
    s_mov_b32 s73, 0
    s_mov_b32 s74, 65558
    s_cmp_ge_u32 s48, 20
    s_cselect_b32 s74, 4194502, s74
    s_cmp_ge_u32 s48, 30
    s_cselect_b32 s74, 39, s74
    s_mov_b32 s69, 22528
    v_mov_b32 v64, 0
    v_mov_b32 v65, 0
    v_mov_b32 v66, 0
    v_mov_b32 v67, 0
    v_mov_b32 v68, 0
    v_mov_b32 v69, 0
    v_mov_b32 v70, 0
    v_mov_b32 v71, 0
    v_mov_b32 v72, 0
    v_mov_b32 v73, 0
    v_mov_b32 v74, 0
    v_mov_b32 v75, 0
    v_mov_b32 v76, 0
    v_mov_b32 v77, 0
    v_mov_b32 v78, 0
    v_mov_b32 v79, 0
    v_mov_b32 v84, 0
    v_mov_b32 v85, 0
    v_mov_b32 v86, 0
    v_mov_b32 v104, 0
    v_mov_b32 v105, 0
    v_mov_b32 v106, 0
    v_mov_b32 v107, 0
    s_mul_i32 s56, s38, 3
    s_add_u32 s56, s56, 0
    s_min_u32 s56, s56, 21
    s_lshl_b32 s66, s56, 10
    s_lshr_b32 s57, s56, 2
    s_add_u32 s58, s7, s57
    s_cmp_eq_u32 s57, 2
    s_cselect_b32 s58, s8, s58
    s_add_u32 s58, s58, 80
    s_mul_i32 s58, s58, 33408
    s_and_b32 s59, s56, 3
    s_lshl_b32 s59, s59, 10
    s_add_u32 s58, s58, s59
    s_mul_i32 s59, s4, 81920
    s_add_u32 s59, s59, s66
    s_add_u32 s59, s59, 5361664
    s_cmp_lt_u32 s56, 12
    s_cselect_b32 s60, s58, s59
    s_cselect_b32 s63, 4, 10
    s_lshl_b32 s63, s63, 10
    s_mul_i32 s56, s38, 3
    s_add_u32 s56, s56, 1
    s_min_u32 s56, s56, 21
    s_lshl_b32 s67, s56, 10
    s_lshr_b32 s57, s56, 2
    s_add_u32 s58, s7, s57
    s_cmp_eq_u32 s57, 2
    s_cselect_b32 s58, s8, s58
    s_add_u32 s58, s58, 80
    s_mul_i32 s58, s58, 33408
    s_and_b32 s59, s56, 3
    s_lshl_b32 s59, s59, 10
    s_add_u32 s58, s58, s59
    s_mul_i32 s59, s4, 81920
    s_add_u32 s59, s59, s67
    s_add_u32 s59, s59, 5361664
    s_cmp_lt_u32 s56, 12
    s_cselect_b32 s61, s58, s59
    s_cselect_b32 s64, 4, 10
    s_lshl_b32 s64, s64, 10
    s_mul_i32 s56, s38, 3
    s_add_u32 s56, s56, 2
    s_min_u32 s56, s56, 21
    s_lshl_b32 s68, s56, 10
    s_lshr_b32 s57, s56, 2
    s_add_u32 s58, s7, s57
    s_cmp_eq_u32 s57, 2
    s_cselect_b32 s58, s8, s58
    s_add_u32 s58, s58, 80
    s_mul_i32 s58, s58, 33408
    s_and_b32 s59, s56, 3
    s_lshl_b32 s59, s59, 10
    s_add_u32 s58, s58, s59
    s_mul_i32 s59, s4, 81920
    s_add_u32 s59, s59, s68
    s_add_u32 s59, s59, 5361664
    s_cmp_lt_u32 s56, 12
    s_cselect_b32 s62, s58, s59
    s_cselect_b32 s65, 4, 10
    s_lshl_b32 s65, s65, 10
    s_lshl_b32 s56, s63, 1
    s_add_u32 s60, s60, s56
    s_lshl_b32 s56, s64, 1
    s_add_u32 s61, s61, s56
    s_lshl_b32 s56, s65, 1
    s_add_u32 s62, s62, s56
    s_cmp_eq_u32 s50, 15
    s_cbranch_scc1 C_ATT
    s_waitcnt vmcnt(8)
    v_cmp_eq_u32 vcc, 0, v49
    s_cbranch_vccz C_NSP_OK
    s_mov_b32 s97, 32768
C_NSP:
    v_mov_b32 v48, 0
    global_load_dword v49, v48, s[36:37] sc1
    s_waitcnt vmcnt(0)
    v_cmp_eq_u32 vcc, 0, v49
    s_cbranch_vccz C_NSP_OK
    s_sleep 8
    s_sub_u32 s97, s97, 1
    s_cmp_lg_u32 s97, 0
    s_cbranch_scc1 C_NSP
C_NSP_OK:
    v_readfirstlane_b32 s55, v49
    v_mov_b32 v48, 153936
    v_mov_b32 v50, 1
    s_waitcnt vmcnt(0)
    s_mov_b64 exec, 1
    ds_write_b32 v48, v49 offset:4
    ds_add_rtn_u32 v51, v48, v50
    s_waitcnt lgkmcnt(0)
    v_cmp_eq_u32 vcc, 3, v51
    s_mov_b64 exec, -1
    s_cbranch_vccz C_NSEND
    s_atomic_swap s55, s[42:43], 0
    s_atomic_swap s55, s[42:43], 1024
    s_atomic_swap s55, s[42:43], 2048
    s_atomic_swap s55, s[42:43], 3072
    s_atomic_swap s55, s[42:43], 4096
    s_atomic_swap s55, s[42:43], 5120
    s_atomic_swap s55, s[42:43], 6144
    s_atomic_swap s55, s[42:43], 7168
C_NSEND:
    s_cmp_lt_u32 s48, 20
    s_cbranch_scc1 C_U
    s_branch C_ATT
C_NOQ:
    s_barrier
    s_cmp_lg_u32 s2, 198
    s_cbranch_scc1 C_NOQ2
    s_cmp_lg_u32 s38, 0
    s_cbranch_scc1 C_NOQ2
    v_mov_b32 v48, 16134144
    buffer_load_dword v49, v48, s[12:15], 0 offen sc1
    s_waitcnt vmcnt(0)
    v_add_u32 v49, 1, v49
    v_max_u32 v49, 1, v49
    v_mov_b32 v50, 0
    s_mov_b64 exec, 1
    global_store_dword v50, v49, s[36:37] sc1
    buffer_store_dword v49, v48, s[12:15], 0 offen sc1
    s_mov_b64 exec, -1
C_NOQ2:
    v_mov_b32 v49, 0
    v_cmp_eq_u32 vcc, 0, v49
    s_cbranch_vccz C_NSP2_OK
    s_mov_b32 s97, 32768
C_NSP2:
    v_mov_b32 v48, 0
    global_load_dword v49, v48, s[36:37] sc1
    s_waitcnt vmcnt(0)
    v_cmp_eq_u32 vcc, 0, v49
    s_cbranch_vccz C_NSP2_OK
    s_sleep 8
    s_sub_u32 s97, s97, 1
    s_cmp_lg_u32 s97, 0
    s_cbranch_scc1 C_NSP2
C_NSP2_OK:
    v_readfirstlane_b32 s55, v49
    v_mov_b32 v48, 153936
    ds_write_b32 v48, v49 offset:4
    s_branch C_SETUP
C_U:
    s_mov_b32 s53, 10
    s_branch C_ULOOP_IN
C_ULOOP:
    s_barrier
C_ULOOP_IN:
    v_mfma_f32_32x32x16_bf16 v[128:143], v[32:35], v[40:43], v[128:143]
    ds_read_b128 v[16:19], v8 offset:0
    ds_read_b128 v[24:27], v56 offset:0
    v_mfma_f32_32x32x16_bf16 v[160:175], v[36:39], v[40:43], v[160:175]
    ds_read_b128 v[20:23], v8 offset:4096
    ds_read_b128 v[28:31], v56 offset:4096
    v_mfma_f32_32x32x16_bf16 v[144:159], v[32:35], v[44:47], v[144:159]
    s_add_u32 s54, s54, 32768
    s_cmp_eq_u32 s54, 131072
    s_cselect_b32 s54, 0, s54
    v_add_u32 v8, s54, v2
    v_add_u32 v56, s54, v52
    v_mfma_f32_32x32x16_bf16 v[176:191], v[36:39], v[44:47], v[176:191]
    s_waitcnt lgkmcnt(0)
    v_mfma_f32_32x32x16_bf16 v[128:143], v[16:19], v[24:27], v[128:143]
    ds_read_b128 v[32:35], v9 offset:0
    ds_read_b128 v[40:43], v57 offset:0
    v_mfma_f32_32x32x16_bf16 v[160:175], v[20:23], v[24:27], v[160:175]
    ds_read_b128 v[36:39], v9 offset:4096
    ds_read_b128 v[44:47], v57 offset:4096
    v_mfma_f32_32x32x16_bf16 v[144:159], v[16:19], v[28:31], v[144:159]
    v_add_u32 v9, s54, v3
    v_add_u32 v57, s54, v53
    v_mfma_f32_32x32x16_bf16 v[176:191], v[20:23], v[28:31], v[176:191]
    s_waitcnt lgkmcnt(0)
    v_mfma_f32_32x32x16_bf16 v[128:143], v[32:35], v[40:43], v[128:143]
    ds_read_b128 v[16:19], v10 offset:0
    ds_read_b128 v[24:27], v58 offset:0
    v_mfma_f32_32x32x16_bf16 v[160:175], v[36:39], v[40:43], v[160:175]
    ds_read_b128 v[20:23], v10 offset:4096
    ds_read_b128 v[28:31], v58 offset:4096
    v_mfma_f32_32x32x16_bf16 v[144:159], v[32:35], v[44:47], v[144:159]
    v_add_u32 v10, s54, v4
    v_add_u32 v58, s54, v54
    v_mfma_f32_32x32x16_bf16 v[176:191], v[36:39], v[44:47], v[176:191]
    s_waitcnt lgkmcnt(0)
    v_mfma_f32_32x32x16_bf16 v[128:143], v[16:19], v[24:27], v[128:143]
    ds_read_b128 v[32:35], v11 offset:0
    ds_read_b128 v[40:43], v59 offset:0
    v_mfma_f32_32x32x16_bf16 v[160:175], v[20:23], v[24:27], v[160:175]
    ds_read_b128 v[36:39], v11 offset:4096
    ds_read_b128 v[44:47], v59 offset:4096
    v_mfma_f32_32x32x16_bf16 v[144:159], v[16:19], v[28:31], v[144:159]
    v_add_u32 v11, s54, v5
    v_add_u32 v59, s54, v55
    s_cmp_lg_u32 s53, 10
    s_cbranch_scc1 C_PARD
    v_lshlrev_b32 v209, 16, v209
    v_lshlrev_b32 v210, 16, v210
    v_lshlrev_b32 v211, 16, v211
    v_mul_f32 v211, 0x3fb8aa3b, v211
    v_exp_f32 v211, v211
    s_nop 0
    v_cvt_pk_bf16_f32 v211, v211, v211
    v_lshlrev_b32 v211, 16, v211
    v_mul_f32 v212, v211, v209
    v_mul_f32 v208, v211, v210
    v_mul_f32 v212, 0x3fb8aa3b, v212
    v_mul_f32 v208, 0x3e22f983, v208
    v_exp_f32 v212, v212
    v_fract_f32 v208, v208
    v_cos_f32 v211, v208
    v_sin_f32 v208, v208
    v_mul_f32 v192, v212, v211
    v_mul_f32 v193, v212, v208
    v_mul_f32 v211, v209, v209
    v_fmac_f32 v211, v210, v210
    v_rcp_f32 v211, v211
    v_subrev_f32 v212, 1.0, v192
    v_add_f32 v211, v211, v211
    v_mul_f32 v208, v212, v209
    v_fmac_f32 v208, v193, v210
    v_mul_f32 v209, v193, v209
    v_fma_f32 v209, -v212, v210, v209
    v_mul_f32 v198, v208, v211
    v_mul_f32 v199, v209, v211
    v_mul_f32 v204, v193, v193
    v_mul_f32 v205, v192, v193
    v_fma_f32 v126, v192, v192, -v204
    v_add_f32 v127, v205, v205
    v_mul_f32 v204, v127, v127
    v_mul_f32 v205, v126, v127
    v_fma_f32 v194, v126, v126, -v204
    v_add_f32 v195, v205, v205
    v_mul_f32 v204, v195, v195
    v_mul_f32 v205, v194, v195
    v_fma_f32 v194, v194, v194, -v204
    v_add_f32 v195, v205, v205
    v_mul_f32 v204, v195, v195
    v_mul_f32 v205, v194, v195
    v_fma_f32 v194, v194, v194, -v204
    v_add_f32 v195, v205, v205
    v_mul_f32 v204, v195, v195
    v_mul_f32 v205, v194, v195
    v_fma_f32 v194, v194, v194, -v204
    v_add_f32 v195, v205, v205
    v_mul_f32 v204, v195, v195
    v_mul_f32 v205, v194, v195
    v_fma_f32 v206, v194, v194, -v204
    v_add_f32 v207, v205, v205
    v_mul_f32 v204, v207, v207
    v_mul_f32 v205, v206, v207
    v_fma_f32 v196, v206, v206, -v204
    v_add_f32 v197, v205, v205
    v_mov_b32 v124, 1.0
    v_mov_b32 v125, 0
    s_mov_b32 s56, 8
C_PHL:
    s_cmp_ge_u32 s56, s51
    s_cbranch_scc1 C_PHD
    v_mul_f32 v204, v125, v197
    v_mul_f32 v205, v125, v196
    v_fma_f32 v204, v124, v196, -v204
    v_fma_f32 v125, v124, v197, v205
    v_mov_b32 v124, v204
    s_add_u32 s56, s56, 1
    s_branch C_PHL
C_PHD:
    v_cmp_eq_u32 vcc, 0, v15
    v_mov_b32 v208, 1.0
    v_mov_b32 v209, 0
    v_cndmask_b32 v202, v194, v208, vcc
    v_cndmask_b32 v203, v195, v209, vcc
    s_cmp_eq_u32 s98, 0
    s_cbranch_scc1 C_PARD
    v_mul_f32 v204, v203, v207
    v_mul_f32 v205, v203, v206
    v_fma_f32 v204, v202, v206, -v204
    v_fma_f32 v203, v202, v207, v205
    v_mov_b32 v202, v204
C_PARD:
    s_sub_u32 s53, s53, 1
    s_cmp_lg_u32 s53, 0
    v_mfma_f32_32x32x16_bf16 v[176:191], v[20:23], v[28:31], v[176:191]
    s_waitcnt lgkmcnt(0)
    s_cbranch_scc1 C_ULOOP
    v_mfma_f32_32x32x16_bf16 v[128:143], v[32:35], v[40:43], v[128:143]
    v_mfma_f32_32x32x16_bf16 v[160:175], v[36:39], v[40:43], v[160:175]
    v_mfma_f32_32x32x16_bf16 v[144:159], v[32:35], v[44:47], v[144:159]
    v_mfma_f32_32x32x16_bf16 v[176:191], v[36:39], v[44:47], v[176:191]
    s_nop 7
    s_nop 3
    .p2align 3
    v_pk_fma_f32 v[20:21], v[128:129], v[126:127], v[130:131] op_sel_hi:[1,0,1]
    v_pk_fma_f32 v[22:23], v[144:145], v[126:127], v[146:147] op_sel_hi:[1,0,1]
    v_pk_fma_f32 v[20:21], v[144:145], v[126:127], v[20:21] op_sel:[0,1,0] op_sel_hi:[1,1,1] neg_lo:[1,0,0] neg_hi:[1,0,0]
    v_pk_fma_f32 v[22:23], v[128:129], v[126:127], v[22:23] op_sel:[0,1,0] op_sel_hi:[1,1,1]
    v_pk_fma_f32 v[16:17], v[20:21], v[126:127], v[132:133] op_sel_hi:[1,0,1]
    v_pk_fma_f32 v[18:19], v[22:23], v[126:127], v[148:149] op_sel_hi:[1,0,1]
    v_pk_fma_f32 v[16:17], v[22:23], v[126:127], v[16:17] op_sel:[0,1,0] op_sel_hi:[1,1,1] neg_lo:[1,0,0] neg_hi:[1,0,0]
    v_pk_fma_f32 v[18:19], v[20:21], v[126:127], v[18:19] op_sel:[0,1,0] op_sel_hi:[1,1,1]
    v_pk_fma_f32 v[20:21], v[16:17], v[126:127], v[134:135] op_sel_hi:[1,0,1]
    v_pk_fma_f32 v[22:23], v[18:19], v[126:127], v[150:151] op_sel_hi:[1,0,1]
    v_pk_fma_f32 v[20:21], v[18:19], v[126:127], v[20:21] op_sel:[0,1,0] op_sel_hi:[1,1,1] neg_lo:[1,0,0] neg_hi:[1,0,0]
    v_pk_fma_f32 v[22:23], v[16:17], v[126:127], v[22:23] op_sel:[0,1,0] op_sel_hi:[1,1,1]
    v_pk_fma_f32 v[16:17], v[20:21], v[126:127], v[136:137] op_sel_hi:[1,0,1]
    v_pk_fma_f32 v[18:19], v[22:23], v[126:127], v[152:153] op_sel_hi:[1,0,1]
    v_pk_fma_f32 v[16:17], v[22:23], v[126:127], v[16:17] op_sel:[0,1,0] op_sel_hi:[1,1,1] neg_lo:[1,0,0] neg_hi:[1,0,0]
    v_pk_fma_f32 v[18:19], v[20:21], v[126:127], v[18:19] op_sel:[0,1,0] op_sel_hi:[1,1,1]
    v_pk_fma_f32 v[20:21], v[16:17], v[126:127], v[138:139] op_sel_hi:[1,0,1]
    v_pk_fma_f32 v[22:23], v[18:19], v[126:127], v[154:155] op_sel_hi:[1,0,1]
    v_pk_fma_f32 v[20:21], v[18:19], v[126:127], v[20:21] op_sel:[0,1,0] op_sel_hi:[1,1,1] neg_lo:[1,0,0] neg_hi:[1,0,0]
    v_pk_fma_f32 v[22:23], v[16:17], v[126:127], v[22:23] op_sel:[0,1,0] op_sel_hi:[1,1,1]
    v_pk_fma_f32 v[16:17], v[20:21], v[126:127], v[140:141] op_sel_hi:[1,0,1]
    v_pk_fma_f32 v[18:19], v[22:23], v[126:127], v[156:157] op_sel_hi:[1,0,1]
    v_pk_fma_f32 v[16:17], v[22:23], v[126:127], v[16:17] op_sel:[0,1,0] op_sel_hi:[1,1,1] neg_lo:[1,0,0] neg_hi:[1,0,0]
    v_pk_fma_f32 v[18:19], v[20:21], v[126:127], v[18:19] op_sel:[0,1,0] op_sel_hi:[1,1,1]
    v_pk_fma_f32 v[20:21], v[16:17], v[126:127], v[142:143] op_sel_hi:[1,0,1]
    v_pk_fma_f32 v[22:23], v[18:19], v[126:127], v[158:159] op_sel_hi:[1,0,1]
    v_pk_fma_f32 v[20:21], v[18:19], v[126:127], v[20:21] op_sel:[0,1,0] op_sel_hi:[1,1,1] neg_lo:[1,0,0] neg_hi:[1,0,0]
    v_pk_fma_f32 v[22:23], v[16:17], v[126:127], v[22:23] op_sel:[0,1,0] op_sel_hi:[1,1,1]
    v_pk_fma_f32 v[16:17], v[20:21], v[126:127], v[160:161] op_sel_hi:[1,0,1]
    v_pk_fma_f32 v[18:19], v[22:23], v[126:127], v[176:177] op_sel_hi:[1,0,1]
    v_pk_fma_f32 v[16:17], v[22:23], v[126:127], v[16:17] op_sel:[0,1,0] op_sel_hi:[1,1,1] neg_lo:[1,0,0] neg_hi:[1,0,0]
    v_pk_fma_f32 v[18:19], v[20:21], v[126:127], v[18:19] op_sel:[0,1,0] op_sel_hi:[1,1,1]
    v_pk_fma_f32 v[20:21], v[16:17], v[126:127], v[162:163] op_sel_hi:[1,0,1]
    v_pk_fma_f32 v[22:23], v[18:19], v[126:127], v[178:179] op_sel_hi:[1,0,1]
    v_pk_fma_f32 v[20:21], v[18:19], v[126:127], v[20:21] op_sel:[0,1,0] op_sel_hi:[1,1,1] neg_lo:[1,0,0] neg_hi:[1,0,0]
    v_pk_fma_f32 v[22:23], v[16:17], v[126:127], v[22:23] op_sel:[0,1,0] op_sel_hi:[1,1,1]
    v_pk_fma_f32 v[16:17], v[20:21], v[126:127], v[164:165] op_sel_hi:[1,0,1]
    v_pk_fma_f32 v[18:19], v[22:23], v[126:127], v[180:181] op_sel_hi:[1,0,1]
    v_pk_fma_f32 v[16:17], v[22:23], v[126:127], v[16:17] op_sel:[0,1,0] op_sel_hi:[1,1,1] neg_lo:[1,0,0] neg_hi:[1,0,0]
    v_pk_fma_f32 v[18:19], v[20:21], v[126:127], v[18:19] op_sel:[0,1,0] op_sel_hi:[1,1,1]
    v_pk_fma_f32 v[20:21], v[16:17], v[126:127], v[166:167] op_sel_hi:[1,0,1]
    v_pk_fma_f32 v[22:23], v[18:19], v[126:127], v[182:183] op_sel_hi:[1,0,1]
    v_pk_fma_f32 v[20:21], v[18:19], v[126:127], v[20:21] op_sel:[0,1,0] op_sel_hi:[1,1,1] neg_lo:[1,0,0] neg_hi:[1,0,0]
    v_pk_fma_f32 v[22:23], v[16:17], v[126:127], v[22:23] op_sel:[0,1,0] op_sel_hi:[1,1,1]
    v_pk_fma_f32 v[16:17], v[20:21], v[126:127], v[168:169] op_sel_hi:[1,0,1]
    v_pk_fma_f32 v[18:19], v[22:23], v[126:127], v[184:185] op_sel_hi:[1,0,1]
    v_pk_fma_f32 v[16:17], v[22:23], v[126:127], v[16:17] op_sel:[0,1,0] op_sel_hi:[1,1,1] neg_lo:[1,0,0] neg_hi:[1,0,0]
    v_pk_fma_f32 v[18:19], v[20:21], v[126:127], v[18:19] op_sel:[0,1,0] op_sel_hi:[1,1,1]
    v_pk_fma_f32 v[20:21], v[16:17], v[126:127], v[170:171] op_sel_hi:[1,0,1]
    v_pk_fma_f32 v[22:23], v[18:19], v[126:127], v[186:187] op_sel_hi:[1,0,1]
    v_pk_fma_f32 v[20:21], v[18:19], v[126:127], v[20:21] op_sel:[0,1,0] op_sel_hi:[1,1,1] neg_lo:[1,0,0] neg_hi:[1,0,0]
    v_pk_fma_f32 v[22:23], v[16:17], v[126:127], v[22:23] op_sel:[0,1,0] op_sel_hi:[1,1,1]
    v_pk_fma_f32 v[16:17], v[20:21], v[126:127], v[172:173] op_sel_hi:[1,0,1]
    v_pk_fma_f32 v[18:19], v[22:23], v[126:127], v[188:189] op_sel_hi:[1,0,1]
    v_pk_fma_f32 v[16:17], v[22:23], v[126:127], v[16:17] op_sel:[0,1,0] op_sel_hi:[1,1,1] neg_lo:[1,0,0] neg_hi:[1,0,0]
    v_pk_fma_f32 v[18:19], v[20:21], v[126:127], v[18:19] op_sel:[0,1,0] op_sel_hi:[1,1,1]
    v_pk_fma_f32 v[20:21], v[16:17], v[126:127], v[174:175] op_sel_hi:[1,0,1]
    v_pk_fma_f32 v[22:23], v[18:19], v[126:127], v[190:191] op_sel_hi:[1,0,1]
    v_pk_fma_f32 v[20:21], v[18:19], v[126:127], v[20:21] op_sel:[0,1,0] op_sel_hi:[1,1,1] neg_lo:[1,0,0] neg_hi:[1,0,0]
    v_pk_fma_f32 v[22:23], v[16:17], v[126:127], v[22:23] op_sel:[0,1,0] op_sel_hi:[1,1,1]
    v_fma_f32 v18, v192, v20, v21
    v_fma_f32 v19, v192, v22, v23
    v_fma_f32 v18, -v193, v22, v18
    v_fma_f32 v19, v193, v20, v19
    s_lshl_b32 s56, s99, 8
    s_add_u32 s56, s56, 65536
    v_lshl_add_u32 v3, v14, 3, s56
    s_lshl_b32 s56, s98, 10
    v_lshl_add_u32 v4, v15, 9, v3
    v_add_u32 v4, s56, v4
    ds_write_b64 v4, v[18:19]
    s_waitcnt lgkmcnt(0)
    s_barrier
    ds_read_b64 v[20:21], v3 offset:0
    ds_read_b64 v[22:23], v3 offset:512
    ds_read_b64 v[24:25], v3 offset:1024
    ds_read_b64 v[26:27], v3 offset:1536
    v_cmp_eq_u32 vcc, 0, v15
    v_mov_b32 v30, 0
    s_cmp_lg_u32 s98, 0
    s_waitcnt lgkmcnt(0)
    v_mov_b32 v28, v20
    v_mov_b32 v29, v21
    s_cbranch_scc1 C_UW1
    v_cndmask_b32 v200, v20, v30, vcc
    v_cndmask_b32 v201, v21, v30, vcc
    v_fma_f32 v204, v194, v28, v22
    v_fma_f32 v205, v194, v29, v23
    v_fma_f32 v204, -v195, v29, v204
    v_fma_f32 v29, v195, v28, v205
    v_mov_b32 v28, v204
    v_fma_f32 v204, v194, v28, v24
    v_fma_f32 v205, v194, v29, v25
    v_fma_f32 v204, -v195, v29, v204
    v_fma_f32 v29, v195, v28, v205
    v_mov_b32 v28, v204
    v_fma_f32 v204, v194, v28, v26
    v_fma_f32 v205, v194, v29, v27
    v_fma_f32 v204, -v195, v29, v204
    v_fma_f32 v29, v195, v28, v205
    v_mov_b32 v28, v204
    v_mov_b32 v30, s55
    v_mov_b32 v31, s55
    v_add_u32 v4, s100, v14
    v_lshlrev_b32 v4, 4, v4
    s_mul_i32 s56, s51, 10240
    s_add_u32 s56, s56, 15925248
    s_mov_b64 exec, 0xffffffff
    buffer_store_dwordx4 v[28:31], v4, s[12:15], s56 offen sc1
    s_mov_b64 exec, -1
    s_branch ATT_START
C_UW1:
    v_fma_f32 v204, v194, v28, v22
    v_fma_f32 v205, v194, v29, v23
    v_fma_f32 v204, -v195, v29, v204
    v_fma_f32 v29, v195, v28, v205
    v_mov_b32 v28, v204
    v_mov_b32 v200, v28
    v_mov_b32 v201, v29
    v_fma_f32 v204, v194, v28, v24
    v_fma_f32 v205, v194, v29, v25
    v_fma_f32 v204, -v195, v29, v204
    v_fma_f32 v29, v195, v28, v205
    v_mov_b32 v28, v204
    v_cndmask_b32 v200, v28, v200, vcc
    v_cndmask_b32 v201, v29, v201, vcc
    s_branch ATT_START
C_ATT:
    s_cmp_lt_u32 s48, 30
    s_cbranch_scc1 C_PRE
    s_lshl_b32 s56, s38, 13
    v_lshl_add_u32 v2, v1, 7, s56
    v_min_u32 v2, PK_END-PK_BEGIN, v2
    global_load_dword v255, v2, s[92:93]
C_ATT2:
    s_waitcnt lgkmcnt(0)
    s_barrier
ATT_START:
    s_setprio 3
    v_add_u32 v108, 131072, v244
    v_add_u32 v109, 131072, v245
    ds_read_b128 v[8:11], v251
    ds_read_b64 v[12:13], v252 offset:8192
    v_mov_b32 v48, 0x3f803f80
    v_mov_b32 v49, 0x3f80
    v_mov_b32 v50, 0x3f803f80
    v_mov_b32 v51, 0x3f80
    s_mov_b64 exec, 0xffffffff
    ds_read2st64_b64 v[48:51], v109 offset0:0 offset1:1
    s_mov_b32 exec_hi, -1
    ds_read_b128 v[96:99], v108
    s_mov_b32 s96, 0x3ea52b5c
    v_cmp_gt_u32 vcc, 32, v1
    s_waitcnt lgkmcnt(2)
    v_lshlrev_b32 v20, 16, v8
    v_and_b32 v21, 0xffff0000, v8
    v_lshlrev_b32 v22, 16, v9
    v_and_b32 v23, 0xffff0000, v9
    v_lshlrev_b32 v24, 16, v10
    v_and_b32 v25, 0xffff0000, v10
    v_lshlrev_b32 v26, 16, v11
    v_and_b32 v27, 0xffff0000, v11
    v_lshlrev_b32 v28, 16, v12
    v_and_b32 v29, 0xffff0000, v12
    v_lshlrev_b32 v30, 16, v13
    v_and_b32 v31, 0xffff0000, v13
    v_pk_mul_f32 v[20:21], v[20:21], s[96:97] op_sel_hi:[1,0]
    v_pk_mul_f32 v[22:23], v[22:23], s[96:97] op_sel_hi:[1,0]
    v_pk_mul_f32 v[24:25], v[24:25], s[96:97] op_sel_hi:[1,0]
    v_pk_mul_f32 v[26:27], v[26:27], s[96:97] op_sel_hi:[1,0]
    v_pk_mul_f32 v[28:29], v[28:29], s[96:97] op_sel_hi:[1,0]
    v_pk_mul_f32 v[30:31], v[30:31], s[96:97] op_sel_hi:[1,0]
    v_cvt_pk_bf16_f32 v92, v28, v29
    v_cvt_pk_bf16_f32 v93, v30, v31
    v_cvt_pk_bf16_f32 v88, v20, v21
    v_cvt_pk_bf16_f32 v89, v22, v23
    v_cvt_pk_bf16_f32 v90, v24, v25
    v_cvt_pk_bf16_f32 v91, v26, v27
    v_cndmask_b32 v92, 0, v92, vcc
    v_cndmask_b32 v93, 0, v93, vcc
    s_waitcnt lgkmcnt(0)
    s_nop 0
    v_mfma_f32_32x32x8_bf16 v[16:31], v[48:49], v[92:93], 0
    v_mfma_f32_32x32x16_bf16 v[16:31], v[96:99], v[88:91], v[16:31]
    v_and_b32 v6, 131072, v247
    v_add_u32 v110, v6, v246
    ds_read_b128 v[96:99], v108 offset:512
    ds_read_b128 v[100:103], v110
    v_mov_b32 v46, 0
    v_mov_b32 v47, 0
    s_mov_b32 s70, 131072
    s_mov_b32 s71, 0
    s_mov_b32 s72, 1
    v_mov_b32 v111, 0
    s_mov_b32 s96, 0x05040100
    s_nop 0
    v_max3_f32 v6, v16, v17, v18
    v_max3_f32 v7, v19, v20, v21
    v_max3_f32 v6, v6, v22, v23
    v_max3_f32 v7, v7, v24, v25
    v_max3_f32 v6, v6, v26, v27
    v_max3_f32 v7, v7, v28, v29
    v_max3_f32 v6, v6, v30, v31
    v_max_f32 v6, v6, v7
    v_mov_b32 v7, v6
    s_nop 1
    v_permlane32_swap_b32 v6, v7
    v_max_f32 v6, v6, v7
    v_pk_add_f32 v[16:17], v[16:17], v[6:7] op_sel_hi:[1,0] neg_lo:[0,1] neg_hi:[0,1]
    v_pk_add_f32 v[18:19], v[18:19], v[6:7] op_sel_hi:[1,0] neg_lo:[0,1] neg_hi:[0,1]
    v_pk_add_f32 v[20:21], v[20:21], v[6:7] op_sel_hi:[1,0] neg_lo:[0,1] neg_hi:[0,1]
    v_pk_add_f32 v[22:23], v[22:23], v[6:7] op_sel_hi:[1,0] neg_lo:[0,1] neg_hi:[0,1]
    v_pk_add_f32 v[24:25], v[24:25], v[6:7] op_sel_hi:[1,0] neg_lo:[0,1] neg_hi:[0,1]
    v_pk_add_f32 v[26:27], v[26:27], v[6:7] op_sel_hi:[1,0] neg_lo:[0,1] neg_hi:[0,1]
    v_pk_add_f32 v[28:29], v[28:29], v[6:7] op_sel_hi:[1,0] neg_lo:[0,1] neg_hi:[0,1]
    v_pk_add_f32 v[30:31], v[30:31], v[6:7] op_sel_hi:[1,0] neg_lo:[0,1] neg_hi:[0,1]
    v_cvt_pk_bf16_f32 v7, -v6, -v6
    v_and_b32 v8, 0xffff0000, v7
    v_add_f32 v6, v6, v8
    v_cvt_pk_bf16_f32 v9, -v6, -v6
    v_and_b32 v8, 0xffff0000, v9
    v_add_f32 v6, v6, v8
    v_cvt_pk_bf16_f32 v6, -v6, 0
    v_perm_b32 v7, v9, v7, s96
    s_mov_b32 exec_lo, 0
    v_mov_b32 v92, v7
    v_mov_b32 v93, v6
    s_mov_b32 exec_lo, -1
    s_branch A_GO2
A_GO:
    v_and_b32 v6, 131072, v247
    v_add_u32 v110, v6, v246
    v_mfma_f32_32x32x8_bf16 v[16:31], v[48:49], v[92:93], 0
    v_mfma_f32_32x32x16_bf16 v[16:31], v[96:99], v[88:91], v[16:31]
    ds_read_b128 v[100:103], v110
    ds_read_b128 v[96:99], v108 offset:512
    s_mov_b32 s70, 131072
    s_mov_b32 s71, 0
    s_mov_b32 s72, 1
    v_mov_b32 v111, 0
    s_nop 4
A_GO2:
    s_waitcnt lgkmcnt(0)
    .p2align 3
A_LOOP:
    v_exp_f32_e64 v16, v16
    v_cvt_pk_bf16_f32 v87, v46, v47
    v_exp_f32 v17, v17
    v_exp_f32 v18, v18
    v_mfma_f32_32x32x8_bf16 v[32:47], v[50:51], v[92:93], 0
    s_mov_b64 exec, 0xffffffff
    ds_read2st64_b64 v[48:51], v109 offset0:2 offset1:3
    s_mov_b32 exec_hi, -1
    s_setprio 2
    s_waitcnt lgkmcnt(2)
    v_exp_f32 v19, v19
    v_cvt_pk_bf16_f32 v80, v16, v17
    v_exp_f32_e64 v20, v20
    v_cvt_pk_bf16_f32 v81, v18, v19
    v_exp_f32 v21, v21
    v_exp_f32 v22, v22
    v_mfma_f32_32x32x16_bf16 v[32:47], v[96:99], v[88:91], v[32:47]
    ds_read_b128 v[96:99], v108 offset:1024
    v_cvt_pk_bf16_f32 v82, v20, v21
    v_exp_f32 v23, v23
    v_exp_f32 v24, v24
    v_cvt_pk_bf16_f32 v83, v22, v23
    v_exp_f32 v25, v25
    v_exp_f32 v26, v26
    v_mfma_f32_32x32x16_bf16 v[64:79], v[104:107], v[84:87], v[64:79]
    ds_read_b128 v[104:107], v110 offset:640
    s_waitcnt lgkmcnt(2)
    v_exp_f32 v27, v27
    v_cvt_pk_bf16_f32 v84, v24, v25
    v_exp_f32_e64 v28, v28
    v_cvt_pk_bf16_f32 v85, v26, v27
    v_exp_f32 v29, v29
    v_exp_f32 v30, v30
    v_mfma_f32_32x32x16_bf16 v[64:79], v[100:103], v[80:83], v[64:79]
    ds_read_b128 v[100:103], v110 offset:1280
    v_cvt_pk_bf16_f32 v86, v28, v29
    v_exp_f32 v31, v31
    v_exp_f32 v32, v32
    v_cvt_pk_bf16_f32 v87, v30, v31
    v_exp_f32 v33, v33
    v_exp_f32 v34, v34
    v_mfma_f32_32x32x8_bf16 v[16:31], v[48:49], v[92:93], 0
    s_waitcnt lgkmcnt(1)
    v_exp_f32 v35, v35
    v_cvt_pk_bf16_f32 v80, v32, v33
    v_exp_f32_e64 v36, v36
    v_cvt_pk_bf16_f32 v81, v34, v35
    v_exp_f32 v37, v37
    v_exp_f32 v38, v38
    v_mfma_f32_32x32x16_bf16 v[16:31], v[96:99], v[88:91], v[16:31]
    ds_read_b128 v[96:99], v108 offset:1536
    v_cvt_pk_bf16_f32 v82, v36, v37
    v_exp_f32 v39, v39
    v_exp_f32 v40, v40
    v_cvt_pk_bf16_f32 v83, v38, v39
    v_exp_f32 v41, v41
    v_exp_f32 v42, v42
    v_mfma_f32_32x32x16_bf16 v[64:79], v[104:107], v[84:87], v[64:79]
    ds_read_b128 v[104:107], v110 offset:1920
    s_waitcnt lgkmcnt(2)
    v_add_u32 v111, 1, v111
    v_cvt_pk_bf16_f32 v84, v40, v41
    v_exp_f32 v43, v43
    v_exp_f32 v44, v44
    v_cvt_pk_bf16_f32 v85, v42, v43
    v_exp_f32 v45, v45
    v_exp_f32 v46, v46
    v_mfma_f32_32x32x16_bf16 v[64:79], v[100:103], v[80:83], v[64:79]
    ds_read_b128 v[100:103], v110 offset:2560
    v_cvt_pk_bf16_f32 v86, v44, v45
    v_exp_f32 v47, v47
    v_exp_f32 v16, v16
    v_cvt_pk_bf16_f32 v87, v46, v47
    v_exp_f32 v17, v17
    v_exp_f32 v18, v18
    v_mfma_f32_32x32x8_bf16 v[32:47], v[50:51], v[92:93], 0
    s_mov_b64 exec, 0xffffffff
    ds_read2st64_b64 v[48:51], v109 offset0:4 offset1:5
    s_mov_b32 exec_hi, -1
    s_cmp_eq_u32 s71, 7
    s_cbranch_scc1 A_WAIT7
    s_waitcnt vmcnt(0)
A_WAITED:
    ds_write_b32 v249, v111
    s_bitcmp1_b32 s74, s71
    s_cbranch_scc1 A_HOOKS
A_HOOKRET:
    s_setprio 1
    s_waitcnt lgkmcnt(3)
    v_cvt_pk_bf16_f32 v80, v16, v17
    v_exp_f32 v19, v19
    v_exp_f32 v20, v20
    v_cvt_pk_bf16_f32 v81, v18, v19
    v_exp_f32 v21, v21
    v_exp_f32 v22, v22
    v_mfma_f32_32x32x16_bf16 v[32:47], v[96:99], v[88:91], v[32:47]
    ds_read_b128 v[96:99], v108 offset:2048
    v_cvt_pk_bf16_f32 v82, v20, v21
    v_exp_f32 v23, v23
    v_exp_f32 v24, v24
    v_cvt_pk_bf16_f32 v83, v22, v23
    v_exp_f32 v25, v25
    v_exp_f32 v26, v26
    v_mfma_f32_32x32x16_bf16 v[64:79], v[104:107], v[84:87], v[64:79]
    ds_read_b128 v[104:107], v110 offset:3200
    s_waitcnt lgkmcnt(3)
    v_exp_f32 v27, v27
    v_cvt_pk_bf16_f32 v84, v24, v25
    v_exp_f32_e64 v28, v28
    v_cvt_pk_bf16_f32 v85, v26, v27
    v_exp_f32 v29, v29
    v_exp_f32 v30, v30
    v_mfma_f32_32x32x16_bf16 v[64:79], v[100:103], v[80:83], v[64:79]
    ds_read_b128 v[100:103], v110 offset:3840
    v_cvt_pk_bf16_f32 v86, v28, v29
    v_exp_f32 v31, v31
    v_exp_f32 v32, v32
    v_cvt_pk_bf16_f32 v87, v30, v31
    v_exp_f32 v33, v33
    v_exp_f32 v34, v34
    v_mfma_f32_32x32x8_bf16 v[16:31], v[48:49], v[92:93], 0
    s_waitcnt lgkmcnt(1)
    v_exp_f32 v35, v35
    v_cvt_pk_bf16_f32 v80, v32, v33
    v_exp_f32_e64 v36, v36
    v_cvt_pk_bf16_f32 v81, v34, v35
    v_exp_f32 v37, v37
    v_exp_f32 v38, v38
    v_mfma_f32_32x32x16_bf16 v[16:31], v[96:99], v[88:91], v[16:31]
    ds_read_b128 v[96:99], v108 offset:2560
    v_cvt_pk_bf16_f32 v82, v36, v37
    v_exp_f32 v39, v39
    v_exp_f32 v40, v40
    v_cvt_pk_bf16_f32 v83, v38, v39
    v_exp_f32 v41, v41
    v_exp_f32 v42, v42
    v_mfma_f32_32x32x16_bf16 v[64:79], v[104:107], v[84:87], v[64:79]
    ds_read_b128 v[104:107], v110 offset:4480
    s_waitcnt lgkmcnt(2)
    v_exp_f32 v43, v43
    v_cvt_pk_bf16_f32 v84, v40, v41
    v_exp_f32_e64 v44, v44
    v_cvt_pk_bf16_f32 v85, v42, v43
    v_exp_f32 v45, v45
    v_exp_f32 v46, v46
    v_mfma_f32_32x32x16_bf16 v[64:79], v[100:103], v[80:83], v[64:79]
    ds_read_b128 v[100:103], v110 offset:5120
    v_cvt_pk_bf16_f32 v86, v44, v45
    v_exp_f32 v47, v47
    v_exp_f32 v16, v16
    v_cvt_pk_bf16_f32 v87, v46, v47
    v_exp_f32 v17, v17
    v_exp_f32 v18, v18
    v_mfma_f32_32x32x8_bf16 v[32:47], v[50:51], v[92:93], 0
    s_mov_b64 exec, 0xffffffff
    ds_read2st64_b64 v[48:51], v109 offset0:6 offset1:7
    s_mov_b32 exec_hi, -1
    s_setprio 0
    s_waitcnt lgkmcnt(2)
    v_exp_f32 v19, v19
    v_cvt_pk_bf16_f32 v80, v16, v17
    v_exp_f32_e64 v20, v20
    v_cvt_pk_bf16_f32 v81, v18, v19
    v_exp_f32 v21, v21
    v_exp_f32 v22, v22
    v_mfma_f32_32x32x16_bf16 v[32:47], v[96:99], v[88:91], v[32:47]
    ds_read_b128 v[96:99], v108 offset:3072
    ds_read_b32 v112, v250
    v_cvt_pk_bf16_f32 v82, v20, v21
    v_exp_f32 v23, v23
    v_exp_f32 v24, v24
    v_cvt_pk_bf16_f32 v83, v22, v23
    v_exp_f32 v25, v25
    v_exp_f32 v26, v26
    v_mfma_f32_32x32x16_bf16 v[64:79], v[104:107], v[84:87], v[64:79]
    ds_read_b128 v[104:107], v110 offset:5760
    s_waitcnt lgkmcnt(3)
    v_exp_f32 v27, v27
    v_cvt_pk_bf16_f32 v84, v24, v25
    v_exp_f32_e64 v28, v28
    v_cvt_pk_bf16_f32 v85, v26, v27
    v_exp_f32 v29, v29
    v_exp_f32 v30, v30
    v_mfma_f32_32x32x16_bf16 v[64:79], v[100:103], v[80:83], v[64:79]
    ds_read_b128 v[100:103], v110 offset:6400
    v_cvt_pk_bf16_f32 v86, v28, v29
    v_exp_f32 v31, v31
    v_exp_f32 v32, v32
    v_cvt_pk_bf16_f32 v87, v30, v31
    v_exp_f32 v33, v33
    v_exp_f32 v34, v34
    v_mfma_f32_32x32x8_bf16 v[16:31], v[48:49], v[92:93], 0
    s_waitcnt lgkmcnt(1)
    v_exp_f32 v35, v35
    v_cvt_pk_bf16_f32 v80, v32, v33
    v_exp_f32_e64 v36, v36
    v_cvt_pk_bf16_f32 v81, v34, v35
    v_exp_f32 v37, v37
    v_exp_f32 v38, v38
    v_mfma_f32_32x32x16_bf16 v[16:31], v[96:99], v[88:91], v[16:31]
    ds_read_b128 v[96:99], v108 offset:3584
    v_cvt_pk_bf16_f32 v82, v36, v37
    v_exp_f32 v39, v39
    v_exp_f32 v40, v40
    v_cvt_pk_bf16_f32 v83, v38, v39
    v_exp_f32 v41, v41
    v_exp_f32 v42, v42
    v_mfma_f32_32x32x16_bf16 v[64:79], v[104:107], v[84:87], v[64:79]
    ds_read_b128 v[104:107], v110 offset:7040
    s_waitcnt lgkmcnt(2)
    v_exp_f32 v43, v43
    v_cvt_pk_bf16_f32 v84, v40, v41
    v_exp_f32_e64 v44, v44
    v_cvt_pk_bf16_f32 v85, v42, v43
    v_exp_f32 v45, v45
    v_exp_f32 v46, v46
    v_mfma_f32_32x32x16_bf16 v[64:79], v[100:103], v[80:83], v[64:79]
    ds_read_b128 v[100:103], v110 offset:7680
    v_cvt_pk_bf16_f32 v86, v44, v45
    v_exp_f32 v47, v47
    v_exp_f32 v16, v16
    v_cvt_pk_bf16_f32 v87, v46, v47
    v_exp_f32 v17, v17
    v_cmp_gt_u32 vcc, s72, v112
    v_exp_f32_e64 v18, v18
    v_mfma_f32_32x32x8_bf16 v[32:47], v[50:51], v[92:93], 0
    s_cmp_eq_u32 s70, 0
    s_cselect_b32 s56, 22528, 0
    s_cmp_eq_u32 s70, 22528
    s_cselect_b32 s70, 131072, s56
    s_cbranch_vccz A_SYNCED
A_POLL:
    s_sleep 1
    ds_read_b32 v112, v250
    s_waitcnt lgkmcnt(0)
    v_cmp_gt_u32 vcc, s72, v112
    s_cbranch_vccnz A_POLL
A_SYNCED:
    s_cmp_gt_u32 s71, 5
    s_cbranch_scc1 A_NODMA
    s_add_u32 m0, s69, s66
    s_nop 0
    buffer_load_dwordx4 v248, s[12:15], s60 offen sc1 lds
    s_add_u32 m0, s69, s67
    s_add_u32 s60, s60, s63
    buffer_load_dwordx4 v248, s[12:15], s61 offen sc1 lds
    s_add_u32 m0, s69, s68
    s_add_u32 s61, s61, s64
    buffer_load_dwordx4 v248, s[12:15], s62 offen sc1 lds
    s_add_u32 s62, s62, s65
    s_cmp_eq_u32 s69, 0
    s_cselect_b32 s56, 22528, 0
    s_cmp_eq_u32 s69, 22528
    s_cselect_b32 s69, 131072, s56
A_NODMA:
    s_lshr_b32 s56, s74, 16
    s_bitcmp1_b32 s56, s71
    s_cbranch_scc1 A_HOOKB
A_HOOKBRET:
    v_add_u32 v109, s70, v245
    v_add_u32_e64 v108, s70, v244
    s_mov_b64 exec, 0xffffffff
    ds_read2st64_b64 v[48:51], v109 offset0:0 offset1:1
    s_mov_b32 exec_hi, -1
    s_setprio 3
    s_waitcnt lgkmcnt(2)
    v_exp_f32 v19, v19
    v_cvt_pk_bf16_f32 v80, v16, v17
    v_exp_f32_e64 v20, v20
    v_cvt_pk_bf16_f32 v81, v18, v19
    v_exp_f32 v21, v21
    v_exp_f32 v22, v22
    v_mfma_f32_32x32x16_bf16 v[32:47], v[96:99], v[88:91], v[32:47]
    ds_read_b128 v[96:99], v108 offset:0
    v_cvt_pk_bf16_f32 v82, v20, v21
    v_exp_f32 v23, v23
    v_exp_f32 v24, v24
    v_cvt_pk_bf16_f32 v83, v22, v23
    v_exp_f32 v25, v25
    v_exp_f32 v26, v26
    v_mfma_f32_32x32x16_bf16 v[64:79], v[104:107], v[84:87], v[64:79]
    ds_read_b128 v[104:107], v110 offset:8320
    s_waitcnt lgkmcnt(2)
    v_exp_f32 v27, v27
    v_cvt_pk_bf16_f32 v84, v24, v25
    v_exp_f32_e64 v28, v28
    v_cvt_pk_bf16_f32 v85, v26, v27
    v_exp_f32 v29, v29
    v_exp_f32 v30, v30
    v_mfma_f32_32x32x16_bf16 v[64:79], v[100:103], v[80:83], v[64:79]
    ds_read_b128 v[100:103], v110 offset:8960
    v_cvt_pk_bf16_f32 v86, v28, v29
    v_exp_f32 v31, v31
    v_exp_f32 v32, v32
    v_cvt_pk_bf16_f32 v87, v30, v31
    v_exp_f32 v33, v33
    v_exp_f32 v34, v34
    v_mfma_f32_32x32x8_bf16 v[16:31], v[48:49], v[92:93], 0
    s_waitcnt lgkmcnt(1)
    v_exp_f32 v35, v35
    v_cvt_pk_bf16_f32 v80, v32, v33
    v_exp_f32_e64 v36, v36
    v_cvt_pk_bf16_f32 v81, v34, v35
    v_exp_f32 v37, v37
    v_exp_f32 v38, v38
    v_mfma_f32_32x32x16_bf16 v[16:31], v[96:99], v[88:91], v[16:31]
    ds_read_b128 v[96:99], v108 offset:512
    v_cvt_pk_bf16_f32 v82, v36, v37
    v_exp_f32 v39, v39
    v_exp_f32 v40, v40
    v_cvt_pk_bf16_f32 v83, v38, v39
    v_exp_f32 v41, v41
    v_exp_f32 v42, v42
    v_mfma_f32_32x32x16_bf16 v[64:79], v[104:107], v[84:87], v[64:79]
    ds_read_b128 v[104:107], v110 offset:9600
    s_waitcnt lgkmcnt(2)
    v_and_b32 v6, s70, v247
    v_add_u32_e64 v110, v6, v246
    v_cvt_pk_bf16_f32 v84, v40, v41
    v_exp_f32 v43, v43
    v_exp_f32 v44, v44
    v_cvt_pk_bf16_f32 v85, v42, v43
    v_exp_f32 v45, v45
    v_exp_f32 v46, v46
    v_mfma_f32_32x32x16_bf16 v[64:79], v[100:103], v[80:83], v[64:79]
    ds_read_b128 v[100:103], v110 offset:0
    s_add_u32 s72, s72, 1
    s_add_u32 s71, s71, 1
    s_cmp_lg_u32 s71, 8
    v_exp_f32 v47, v47
    v_cvt_pk_bf16_f32 v86, v44, v45
    s_cbranch_scc1 A_LOOP
    s_waitcnt lgkmcnt(0)
    v_cvt_pk_bf16_f32 v87, v46, v47
    s_mul_i32 s10, s7, 33408
    s_add_u32 s10, s10, s9
    v_mfma_f32_32x32x16_bf16 v[64:79], v[104:107], v[84:87], v[64:79]
    s_add_u32 s10, s10, 7995392
    s_mul_i32 s11, s8, 33408
    s_add_u32 s11, s11, s9
    s_lshl_b32 s56, s6, 3
    s_add_u32 s11, s11, s56
    s_add_u32 s11, s11, 7995392
    s_mov_b32 s96, 0x71800000
    v_mov_b32 v19, 153952
    s_lshl_b32 s56, s5, 7
    s_lshl_b32 s57, s4, 2
    s_add_u32 s56, s56, s57
    s_add_u32 s75, s56, 16138240
    v_mov_b32 v6, v72
    v_mov_b32 v7, v72
    s_nop 1
    v_permlane32_swap_b32 v6, v7
    v_rcp_f32 v6, v7
    s_nop 0
    v_cmp_nlt_f32 s[58:59], v7, s96
    v_pk_mul_f32 v[64:65], v[64:65], v[6:7] op_sel_hi:[1,0]
    v_pk_mul_f32 v[66:67], v[66:67], v[6:7] op_sel_hi:[1,0]
    v_pk_mul_f32 v[68:69], v[68:69], v[6:7] op_sel_hi:[1,0]
    v_pk_mul_f32 v[70:71], v[70:71], v[6:7] op_sel_hi:[1,0]
    v_pk_mul_f32 v[72:73], v[72:73], v[6:7] op_sel_hi:[1,0]
    v_pk_mul_f32 v[74:75], v[74:75], v[6:7] op_sel_hi:[1,0]
    v_cvt_pk_bf16_f32 v80, v64, v65
    v_cvt_pk_bf16_f32 v81, v66, v67
    v_cvt_pk_bf16_f32 v82, v68, v69
    v_cvt_pk_bf16_f32 v83, v70, v71
    v_cvt_pk_bf16_f32 v84, v72, v73
    v_cvt_pk_bf16_f32 v85, v74, v75
    v_pk_mul_f32 v[8:9], v[64:65], 0 op_sel_hi:[1,0]
    v_pk_fma_f32 v[8:9], v[66:67], 0, v[8:9] op_sel_hi:[1,0,1]
    v_pk_fma_f32 v[8:9], v[68:69], 0, v[8:9] op_sel_hi:[1,0,1]
    v_pk_fma_f32 v[8:9], v[70:71], 0, v[8:9] op_sel_hi:[1,0,1]
    v_pk_fma_f32 v[8:9], v[72:73], 0, v[8:9] op_sel_hi:[1,0,1]
    v_pk_fma_f32 v[8:9], v[74:75], 0, v[8:9] op_sel_hi:[1,0,1]
    v_permlane32_swap_b32 v80, v82
    v_permlane32_swap_b32 v81, v83
    v_cmp_u_f32 vcc, v8, v9
    buffer_store_dwordx4 v[80:83], v254, s[12:15], s10 offen sc1
    s_mov_b64 exec, 0xffffffff
    buffer_store_dwordx2 v[84:85], v253, s[12:15], s11 offen sc1
    s_mov_b64 exec, -1
    s_setprio 0
    s_or_b64 vcc, vcc, s[58:59]
    s_cbranch_scc0 A_VOTED
    s_cmp_lg_u32 s73, 0
    s_cbranch_scc1 A_VOTED
    v_mov_b32 v18, 1
    ds_write_b32 v19, v18
A_VOTED:
    s_cmp_lt_u32 s48, 20
    s_cselect_b32 s56, 0, s48
    s_cmp_ge_u32 s48, 30
    s_cselect_b32 s56, 0, s56
    s_cmp_lg_u32 s56, 0
    s_cbranch_scc1 A_CV
    s_waitcnt vmcnt(0) lgkmcnt(0)
    s_branch A_BV
A_CV:
    s_waitcnt vmcnt(2) lgkmcnt(0)
A_BV:
    s_barrier
    ds_read_b32 v18, v19
    s_waitcnt lgkmcnt(0)
    v_cmp_ne_u32 vcc, 0, v18
    s_cbranch_vccnz A_FALLBACK
    s_cmp_lt_u32 s48, 20
    s_cbranch_scc1 W_PHASE
    s_cmp_lt_u32 s48, 30
    s_cbranch_scc1 C_PHASE
    s_cmp_lg_u32 s38, 4
    s_cbranch_scc1 PK_FIN
    v_lshlrev_b32 v6, 10, v1
    v_mov_b32 v7, s55
    s_mov_b64 exec, 15
    buffer_store_dword v7, v6, s[12:15], s75 offen sc1
    s_mov_b64 exec, -1
    s_branch PK_FIN
A_FALLBACK:
    s_barrier
    v_mov_b32 v18, 0
    ds_write_b32 v19, v18
    s_add_u32 s10, s7, 80
    s_mul_i32 s10, s10, 33408
    s_add_u32 s11, s8, 80
    s_mul_i32 s11, s11, 33408
    v_subrev_u32 v6, 8192, v245
    v_mov_b32 v7, 0xff800000
    s_mov_b32 s71, 64
    s_mov_b32 exec_lo, 0
    v_mov_b32 v92, 0
    v_mov_b32 v93, 0
    s_mov_b32 exec_lo, -1
A_FB:
    s_mov_b32 exec_hi, 0
    buffer_load_dwordx2 v[48:49], v6, s[12:15], s11 offen sc1
    s_mov_b32 exec_hi, -1
    buffer_load_dwordx4 v[96:99], v254, s[12:15], s10 offen sc1
    s_add_u32 s10, s10, 512
    s_add_u32 s11, s11, 512
    s_waitcnt vmcnt(0)
    v_mfma_f32_32x32x8_bf16 v[16:31], v[48:49], v[92:93], 0
    v_mfma_f32_32x32x16_bf16 v[16:31], v[96:99], v[88:91], v[16:31]
    s_nop 11
    v_max3_f32 v7, v7, v16, v17
    v_max3_f32 v7, v7, v18, v19
    v_max3_f32 v7, v7, v20, v21
    v_max3_f32 v7, v7, v22, v23
    v_max3_f32 v7, v7, v24, v25
    v_max3_f32 v7, v7, v26, v27
    v_max3_f32 v7, v7, v28, v29
    v_max3_f32 v7, v7, v30, v31
    s_sub_u32 s71, s71, 1
    s_cmp_lg_u32 s71, 0
    s_cbranch_scc1 A_FB
    v_mov_b32 v6, v7
    v_mov_b32 v8, 0
    ds_write_b32 v249, v8
    v_permlane32_swap_b32 v6, v7
    v_max_f32 v6, v6, v7
    s_mov_b32 s96, 0x05040100
    v_cvt_pk_bf16_f32 v7, -v6, -v6
    v_and_b32 v8, 0xffff0000, v7
    v_add_f32 v6, v6, v8
    v_cvt_pk_bf16_f32 v9, -v6, -v6
    v_and_b32 v8, 0xffff0000, v9
    v_add_f32 v6, v6, v8
    v_cvt_pk_bf16_f32 v6, -v6, 0
    v_perm_b32 v7, v9, v7, s96
    s_mov_b32 exec_lo, 0
    v_mov_b32 v92, v7
    v_mov_b32 v93, v6
    s_mov_b32 exec_lo, -1
    v_mov_b32 v64, 0
    v_mov_b32 v65, 0
    v_mov_b32 v66, 0
    v_mov_b32 v67, 0
    v_mov_b32 v68, 0
    v_mov_b32 v69, 0
    v_mov_b32 v70, 0
    v_mov_b32 v71, 0
    v_mov_b32 v72, 0
    v_mov_b32 v73, 0
    v_mov_b32 v74, 0
    v_mov_b32 v75, 0
    v_mov_b32 v76, 0
    v_mov_b32 v77, 0
    v_mov_b32 v78, 0
    v_mov_b32 v79, 0
    v_mov_b32 v84, 0
    v_mov_b32 v85, 0
    v_mov_b32 v86, 0
    v_mov_b32 v104, 0
    v_mov_b32 v105, 0
    v_mov_b32 v106, 0
    v_mov_b32 v107, 0
    v_mov_b32 v46, 0
    v_mov_b32 v47, 0
    s_mul_i32 s56, s38, 3
    s_add_u32 s56, s56, 0
    s_min_u32 s56, s56, 21
    s_lshl_b32 s66, s56, 10
    s_lshr_b32 s57, s56, 2
    s_add_u32 s58, s7, s57
    s_cmp_eq_u32 s57, 2
    s_cselect_b32 s58, s8, s58
    s_add_u32 s58, s58, 80
    s_mul_i32 s58, s58, 33408
    s_and_b32 s59, s56, 3
    s_lshl_b32 s59, s59, 10
    s_add_u32 s58, s58, s59
    s_mul_i32 s59, s4, 81920
    s_add_u32 s59, s59, s66
    s_add_u32 s59, s59, 5361664
    s_cmp_lt_u32 s56, 12
    s_cselect_b32 s60, s58, s59
    s_cselect_b32 s63, 4, 10
    s_lshl_b32 s63, s63, 10
    s_mul_i32 s56, s38, 3
    s_add_u32 s56, s56, 1
    s_min_u32 s56, s56, 21
    s_lshl_b32 s67, s56, 10
    s_lshr_b32 s57, s56, 2
    s_add_u32 s58, s7, s57
    s_cmp_eq_u32 s57, 2
    s_cselect_b32 s58, s8, s58
    s_add_u32 s58, s58, 80
    s_mul_i32 s58, s58, 33408
    s_and_b32 s59, s56, 3
    s_lshl_b32 s59, s59, 10
    s_add_u32 s58, s58, s59
    s_mul_i32 s59, s4, 81920
    s_add_u32 s59, s59, s67
    s_add_u32 s59, s59, 5361664
    s_cmp_lt_u32 s56, 12
    s_cselect_b32 s61, s58, s59
    s_cselect_b32 s64, 4, 10
    s_lshl_b32 s64, s64, 10
    s_mul_i32 s56, s38, 3
    s_add_u32 s56, s56, 2
    s_min_u32 s56, s56, 21
    s_lshl_b32 s68, s56, 10
    s_lshr_b32 s57, s56, 2
    s_add_u32 s58, s7, s57
    s_cmp_eq_u32 s57, 2
    s_cselect_b32 s58, s8, s58
    s_add_u32 s58, s58, 80
    s_mul_i32 s58, s58, 33408
    s_and_b32 s59, s56, 3
    s_lshl_b32 s59, s59, 10
    s_add_u32 s58, s58, s59
    s_mul_i32 s59, s4, 81920
    s_add_u32 s59, s59, s68
    s_add_u32 s59, s59, 5361664
    s_cmp_lt_u32 s56, 12
    s_cselect_b32 s62, s58, s59
    s_cselect_b32 s65, 4, 10
    s_lshl_b32 s65, s65, 10
    s_mov_b32 s69, 131072
    s_add_u32 m0, s69, s66
    s_nop 0
    buffer_load_dwordx4 v248, s[12:15], s60 offen sc1 lds
    s_add_u32 m0, s69, s67
    s_add_u32 s60, s60, s63
    buffer_load_dwordx4 v248, s[12:15], s61 offen sc1 lds
    s_add_u32 m0, s69, s68
    s_add_u32 s61, s61, s64
    buffer_load_dwordx4 v248, s[12:15], s62 offen sc1 lds
    s_add_u32 s62, s62, s65
    s_cmp_eq_u32 s69, 0
    s_cselect_b32 s56, 22528, 0
    s_cmp_eq_u32 s69, 22528
    s_cselect_b32 s69, 131072, s56
    s_add_u32 m0, s69, s66
    s_nop 0
    buffer_load_dwordx4 v248, s[12:15], s60 offen sc1 lds
    s_add_u32 m0, s69, s67
    s_add_u32 s60, s60, s63
    buffer_load_dwordx4 v248, s[12:15], s61 offen sc1 lds
    s_add_u32 m0, s69, s68
    s_add_u32 s61, s61, s64
    buffer_load_dwordx4 v248, s[12:15], s62 offen sc1 lds
    s_add_u32 s62, s62, s65
    s_cmp_eq_u32 s69, 0
    s_cselect_b32 s56, 22528, 0
    s_cmp_eq_u32 s69, 22528
    s_cselect_b32 s69, 131072, s56
    s_mov_b32 s73, 1
    s_mov_b32 s74, 0
    v_add_u32 v108, 131072, v244
    v_add_u32 v109, 131072, v245
    s_waitcnt vmcnt(0) lgkmcnt(0)
    s_barrier
    s_mov_b64 exec, 0xffffffff
    ds_read2st64_b64 v[48:51], v109 offset0:0 offset1:1
    s_mov_b32 exec_hi, -1
    ds_read_b128 v[96:99], v108
    s_waitcnt lgkmcnt(0)
    s_branch A_GO
A_WAIT7:
    s_cmp_lt_u32 s48, 20
    s_cbranch_scc1 A_WAITED
    s_branch A_WAITED
A_HOOKS:
    s_cmp_ge_u32 s48, 20
    s_cbranch_scc1 HK_CWG
    s_cmp_ge_u32 s38, 4
    s_cbranch_scc1 HK_WO
    s_cmp_gt_u32 s71, 3
    s_cbranch_scc1 HK_WS
    s_cmp_eq_u32 s71, 2
    s_cbranch_scc1 HK_FLAGH
    s_branch HK_LB2
A_HOOKB:
    s_cmp_eq_u32 s71, 7
    s_cbranch_scc1 HK_R4
    s_cmp_ge_u32 s48, 20
    s_cbranch_scc1 HK_C2
    v_add_u32 v240, s100, v14
    v_lshlrev_b32 v240, 4, v240
    v_mul_u32_u24 v241, 81920, v15
    v_add_u32 v241, v241, v240
    s_mov_b32 s56, 15925248
    buffer_load_dwordx4 v[208:211], v241, s[12:15], s56 offen sc1
    s_mov_b32 s56, 15935488
    buffer_load_dwordx4 v[212:215], v241, s[12:15], s56 offen sc1
    s_mov_b32 s56, 15945728
    buffer_load_dwordx4 v[216:219], v241, s[12:15], s56 offen sc1
    s_mov_b32 s56, 15955968
    buffer_load_dwordx4 v[220:223], v241, s[12:15], s56 offen sc1
    s_mov_b32 s56, 15966208
    buffer_load_dwordx4 v[224:227], v241, s[12:15], s56 offen sc1
    s_mov_b32 s56, 15976448
    buffer_load_dwordx4 v[228:231], v241, s[12:15], s56 offen sc1
    s_mov_b32 s56, 15986688
    buffer_load_dwordx4 v[232:235], v241, s[12:15], s56 offen sc1
    s_mov_b32 s56, 15996928
    buffer_load_dwordx4 v[236:239], v241, s[12:15], s56 offen sc1
    s_branch A_HOOKBRET
HK_LB2:
    v_add_u32 v240, s100, v14
    v_lshlrev_b32 v240, 4, v240
    s_mov_b32 s97, 32768
HK_LBR:
    v_mov_b32 v206, 0
    v_mov_b32 v207, 0
    s_mov_b64 s[10:11], 0
    s_cmp_le_u32 s51, 0
    s_cbranch_scc1 HK_LBNEXT
    s_cmp_gt_u32 s51, 8
    s_cselect_b32 exec_hi, -1, 0
    v_cmp_ne_u32 vcc, s55, v210
    v_fma_f32 v204, v196, v206, v208
    v_fma_f32 v205, v196, v207, v209
    v_fma_f32 v204, -v197, v207, v204
    v_fma_f32 v207, v197, v206, v205
    v_mov_b32 v206, v204
    s_or_b64 s[10:11], s[10:11], vcc
    s_cmp_le_u32 s51, 1
    s_cbranch_scc1 HK_LBNEXT
    s_cmp_gt_u32 s51, 9
    s_cselect_b32 exec_hi, -1, 0
    v_cmp_ne_u32 vcc, s55, v214
    v_fma_f32 v204, v196, v206, v212
    v_fma_f32 v205, v196, v207, v213
    v_fma_f32 v204, -v197, v207, v204
    v_fma_f32 v207, v197, v206, v205
    v_mov_b32 v206, v204
    s_or_b64 s[10:11], s[10:11], vcc
    s_cmp_le_u32 s51, 2
    s_cbranch_scc1 HK_LBNEXT
    s_cmp_gt_u32 s51, 10
    s_cselect_b32 exec_hi, -1, 0
    v_cmp_ne_u32 vcc, s55, v218
    v_fma_f32 v204, v196, v206, v216
    v_fma_f32 v205, v196, v207, v217
    v_fma_f32 v204, -v197, v207, v204
    v_fma_f32 v207, v197, v206, v205
    v_mov_b32 v206, v204
    s_or_b64 s[10:11], s[10:11], vcc
    s_cmp_le_u32 s51, 3
    s_cbranch_scc1 HK_LBNEXT
    s_cmp_gt_u32 s51, 11
    s_cselect_b32 exec_hi, -1, 0
    v_cmp_ne_u32 vcc, s55, v222
    v_fma_f32 v204, v196, v206, v220
    v_fma_f32 v205, v196, v207, v221
    v_fma_f32 v204, -v197, v207, v204
    v_fma_f32 v207, v197, v206, v205
    v_mov_b32 v206, v204
    s_or_b64 s[10:11], s[10:11], vcc
    s_cmp_le_u32 s51, 4
    s_cbranch_scc1 HK_LBNEXT
    s_cmp_gt_u32 s51, 12
    s_cselect_b32 exec_hi, -1, 0
    v_cmp_ne_u32 vcc, s55, v226
    v_fma_f32 v204, v196, v206, v224
    v_fma_f32 v205, v196, v207, v225
    v_fma_f32 v204, -v197, v207, v204
    v_fma_f32 v207, v197, v206, v205
    v_mov_b32 v206, v204
    s_or_b64 s[10:11], s[10:11], vcc
    s_cmp_le_u32 s51, 5
    s_cbranch_scc1 HK_LBNEXT
    s_cmp_gt_u32 s51, 13
    s_cselect_b32 exec_hi, -1, 0
    v_cmp_ne_u32 vcc, s55, v230
    v_fma_f32 v204, v196, v206, v228
    v_fma_f32 v205, v196, v207, v229
    v_fma_f32 v204, -v197, v207, v204
    v_fma_f32 v207, v197, v206, v205
    v_mov_b32 v206, v204
    s_or_b64 s[10:11], s[10:11], vcc
    s_cmp_le_u32 s51, 6
    s_cbranch_scc1 HK_LBNEXT
    s_cmp_gt_u32 s51, 14
    s_cselect_b32 exec_hi, -1, 0
    v_cmp_ne_u32 vcc, s55, v234
    v_fma_f32 v204, v196, v206, v232
    v_fma_f32 v205, v196, v207, v233
    v_fma_f32 v204, -v197, v207, v204
    v_fma_f32 v207, v197, v206, v205
    v_mov_b32 v206, v204
    s_or_b64 s[10:11], s[10:11], vcc
    s_cmp_le_u32 s51, 7
    s_cbranch_scc1 HK_LBNEXT
    s_cmp_gt_u32 s51, 15
    s_cselect_b32 exec_hi, -1, 0
    v_cmp_ne_u32 vcc, s55, v238
    v_fma_f32 v204, v196, v206, v236
    v_fma_f32 v205, v196, v207, v237
    v_fma_f32 v204, -v197, v207, v204
    v_fma_f32 v207, v197, v206, v205
    v_mov_b32 v206, v204
    s_or_b64 s[10:11], s[10:11], vcc
HK_LBNEXT:
    s_mov_b64 exec, -1
    s_cmp_eq_u64 s[10:11], 0
    s_cbranch_scc1 HK_LBOK
    s_sub_u32 s97, s97, 1
    s_cmp_eq_u32 s97, 0
    s_cbranch_scc1 HK_LBOK
    s_sleep 8
    v_mul_u32_u24 v241, 81920, v15
    v_add_u32 v241, v241, v240
    s_mov_b32 s56, 15925248
    buffer_load_dwordx4 v[208:211], v241, s[12:15], s56 offen sc1
    s_mov_b32 s56, 15935488
    buffer_load_dwordx4 v[212:215], v241, s[12:15], s56 offen sc1
    s_mov_b32 s56, 15945728
    buffer_load_dwordx4 v[216:219], v241, s[12:15], s56 offen sc1
    s_mov_b32 s56, 15955968
    buffer_load_dwordx4 v[220:223], v241, s[12:15], s56 offen sc1
    s_mov_b32 s56, 15966208
    buffer_load_dwordx4 v[224:227], v241, s[12:15], s56 offen sc1
    s_mov_b32 s56, 15976448
    buffer_load_dwordx4 v[228:231], v241, s[12:15], s56 offen sc1
    s_mov_b32 s56, 15986688
    buffer_load_dwordx4 v[232:235], v241, s[12:15], s56 offen sc1
    s_mov_b32 s56, 15996928
    buffer_load_dwordx4 v[236:239], v241, s[12:15], s56 offen sc1
    s_waitcnt vmcnt(0)
    s_branch HK_LBR
HK_LBOK:
    v_mov_b32 v208, v206
    v_mov_b32 v209, v207
    s_nop 0
    v_permlane32_swap_b32 v206, v208
    v_permlane32_swap_b32 v207, v209
    v_fma_f32 v204, v124, v206, v208
    v_fma_f32 v205, v124, v207, v209
    v_fma_f32 v204, -v125, v207, v204
    v_fma_f32 v207, v125, v206, v205
    v_mov_b32 v206, v204
    v_fma_f32 v204, v202, v206, v200
    v_fma_f32 v205, v202, v207, v201
    v_fma_f32 v204, -v203, v207, v204
    v_fma_f32 v207, v203, v206, v205
    v_mov_b32 v206, v204
    s_branch HK_P2
    .p2align 6
HK_P2:
    v_fma_f32 v128, v192, v206, v128
    v_fma_f32 v144, v192, v207, v144
    v_fma_f32 v128, -v193, v207, v128
    v_fma_f32 v144, v193, v206, v144
    v_fma_f32 v129, v192, v128, v129
    v_fma_f32 v145, v192, v144, v145
    v_fma_f32 v129, -v193, v144, v129
    v_fma_f32 v145, v193, v128, v145
    v_fma_f32 v130, v192, v129, v130
    v_fma_f32 v146, v192, v145, v146
    v_fma_f32 v130, -v193, v145, v130
    v_fma_f32 v146, v193, v129, v146
    v_fma_f32 v131, v192, v130, v131
    v_fma_f32 v147, v192, v146, v147
    v_fma_f32 v131, -v193, v146, v131
    v_fma_f32 v147, v193, v130, v147
    v_fma_f32 v132, v192, v131, v132
    v_fma_f32 v148, v192, v147, v148
    v_fma_f32 v132, -v193, v147, v132
    v_fma_f32 v148, v193, v131, v148
    v_fma_f32 v133, v192, v132, v133
    v_fma_f32 v149, v192, v148, v149
    v_fma_f32 v133, -v193, v148, v133
    v_fma_f32 v149, v193, v132, v149
    v_fma_f32 v134, v192, v133, v134
    v_fma_f32 v150, v192, v149, v150
    v_fma_f32 v134, -v193, v149, v134
    v_fma_f32 v150, v193, v133, v150
    v_fma_f32 v135, v192, v134, v135
    v_fma_f32 v151, v192, v150, v151
    v_fma_f32 v135, -v193, v150, v135
    v_fma_f32 v151, v193, v134, v151
    v_fma_f32 v136, v192, v135, v136
    v_fma_f32 v152, v192, v151, v152
    v_fma_f32 v136, -v193, v151, v136
    v_fma_f32 v152, v193, v135, v152
    v_fma_f32 v137, v192, v136, v137
    v_fma_f32 v153, v192, v152, v153
    v_fma_f32 v137, -v193, v152, v137
    v_fma_f32 v153, v193, v136, v153
    v_fma_f32 v138, v192, v137, v138
    v_fma_f32 v154, v192, v153, v154
    v_fma_f32 v138, -v193, v153, v138
    v_fma_f32 v154, v193, v137, v154
    v_fma_f32 v139, v192, v138, v139
    v_fma_f32 v155, v192, v154, v155
    v_fma_f32 v139, -v193, v154, v139
    v_fma_f32 v155, v193, v138, v155
    v_fma_f32 v140, v192, v139, v140
    v_fma_f32 v156, v192, v155, v156
    v_fma_f32 v140, -v193, v155, v140
    v_fma_f32 v156, v193, v139, v156
    v_fma_f32 v141, v192, v140, v141
    v_fma_f32 v157, v192, v156, v157
    v_fma_f32 v141, -v193, v156, v141
    v_fma_f32 v157, v193, v140, v157
    v_fma_f32 v142, v192, v141, v142
    v_fma_f32 v158, v192, v157, v158
    v_fma_f32 v142, -v193, v157, v142
    v_fma_f32 v158, v193, v141, v158
    v_fma_f32 v143, v192, v142, v143
    v_fma_f32 v159, v192, v158, v159
    v_fma_f32 v143, -v193, v158, v143
    v_fma_f32 v159, v193, v142, v159
    v_pk_mul_f32 v[116:117], v[144:145], v[198:199] op_sel:[0,1] op_sel_hi:[1,1]
    v_pk_mul_f32 v[118:119], v[144:145], v[198:199] op_sel_hi:[1,0]
    v_pk_fma_f32 v[116:117], v[128:129], v[198:199], v[116:117] op_sel_hi:[1,0,1] neg_lo:[0,0,1] neg_hi:[0,0,1]
    v_pk_fma_f32 v[118:119], v[128:129], v[198:199], v[118:119] op_sel:[0,1,0] op_sel_hi:[1,1,1]
    v_cvt_pk_bf16_f32 v208, v116, v117
    v_cvt_pk_bf16_f32 v216, -v118, -v119
    v_pk_mul_f32 v[120:121], v[146:147], v[198:199] op_sel:[0,1] op_sel_hi:[1,1]
    v_pk_mul_f32 v[122:123], v[146:147], v[198:199] op_sel_hi:[1,0]
    v_pk_fma_f32 v[120:121], v[130:131], v[198:199], v[120:121] op_sel_hi:[1,0,1] neg_lo:[0,0,1] neg_hi:[0,0,1]
    v_pk_fma_f32 v[122:123], v[130:131], v[198:199], v[122:123] op_sel:[0,1,0] op_sel_hi:[1,1,1]
    v_cvt_pk_bf16_f32 v209, v120, v121
    v_cvt_pk_bf16_f32 v217, -v122, -v123
    v_pk_mul_f32 v[116:117], v[148:149], v[198:199] op_sel:[0,1] op_sel_hi:[1,1]
    v_pk_mul_f32 v[118:119], v[148:149], v[198:199] op_sel_hi:[1,0]
    v_pk_fma_f32 v[116:117], v[132:133], v[198:199], v[116:117] op_sel_hi:[1,0,1] neg_lo:[0,0,1] neg_hi:[0,0,1]
    v_pk_fma_f32 v[118:119], v[132:133], v[198:199], v[118:119] op_sel:[0,1,0] op_sel_hi:[1,1,1]
    v_cvt_pk_bf16_f32 v210, v116, v117
    v_cvt_pk_bf16_f32 v218, -v118, -v119
    v_pk_mul_f32 v[120:121], v[150:151], v[198:199] op_sel:[0,1] op_sel_hi:[1,1]
    v_pk_mul_f32 v[122:123], v[150:151], v[198:199] op_sel_hi:[1,0]
    v_pk_fma_f32 v[120:121], v[134:135], v[198:199], v[120:121] op_sel_hi:[1,0,1] neg_lo:[0,0,1] neg_hi:[0,0,1]
    v_pk_fma_f32 v[122:123], v[134:135], v[198:199], v[122:123] op_sel:[0,1,0] op_sel_hi:[1,1,1]
    v_cvt_pk_bf16_f32 v211, v120, v121
    v_cvt_pk_bf16_f32 v219, -v122, -v123
    v_pk_mul_f32 v[116:117], v[152:153], v[198:199] op_sel:[0,1] op_sel_hi:[1,1]
    v_pk_mul_f32 v[118:119], v[152:153], v[198:199] op_sel_hi:[1,0]
    v_pk_fma_f32 v[116:117], v[136:137], v[198:199], v[116:117] op_sel_hi:[1,0,1] neg_lo:[0,0,1] neg_hi:[0,0,1]
    v_pk_fma_f32 v[118:119], v[136:137], v[198:199], v[118:119] op_sel:[0,1,0] op_sel_hi:[1,1,1]
    v_cvt_pk_bf16_f32 v212, v116, v117
    v_cvt_pk_bf16_f32 v220, -v118, -v119
    v_pk_mul_f32 v[120:121], v[154:155], v[198:199] op_sel:[0,1] op_sel_hi:[1,1]
    v_pk_mul_f32 v[122:123], v[154:155], v[198:199] op_sel_hi:[1,0]
    v_pk_fma_f32 v[120:121], v[138:139], v[198:199], v[120:121] op_sel_hi:[1,0,1] neg_lo:[0,0,1] neg_hi:[0,0,1]
    v_pk_fma_f32 v[122:123], v[138:139], v[198:199], v[122:123] op_sel:[0,1,0] op_sel_hi:[1,1,1]
    v_cvt_pk_bf16_f32 v213, v120, v121
    v_cvt_pk_bf16_f32 v221, -v122, -v123
    v_pk_mul_f32 v[116:117], v[156:157], v[198:199] op_sel:[0,1] op_sel_hi:[1,1]
    v_pk_mul_f32 v[118:119], v[156:157], v[198:199] op_sel_hi:[1,0]
    v_pk_fma_f32 v[116:117], v[140:141], v[198:199], v[116:117] op_sel_hi:[1,0,1] neg_lo:[0,0,1] neg_hi:[0,0,1]
    v_pk_fma_f32 v[118:119], v[140:141], v[198:199], v[118:119] op_sel:[0,1,0] op_sel_hi:[1,1,1]
    v_cvt_pk_bf16_f32 v214, v116, v117
    v_cvt_pk_bf16_f32 v222, -v118, -v119
    v_pk_mul_f32 v[120:121], v[158:159], v[198:199] op_sel:[0,1] op_sel_hi:[1,1]
    v_pk_mul_f32 v[122:123], v[158:159], v[198:199] op_sel_hi:[1,0]
    v_pk_fma_f32 v[120:121], v[142:143], v[198:199], v[120:121] op_sel_hi:[1,0,1] neg_lo:[0,0,1] neg_hi:[0,0,1]
    v_pk_fma_f32 v[122:123], v[142:143], v[198:199], v[122:123] op_sel:[0,1,0] op_sel_hi:[1,1,1]
    v_cvt_pk_bf16_f32 v215, v120, v121
    v_cvt_pk_bf16_f32 v223, -v122, -v123
    v_mul_u32_u24 v241, 81920, v15
    v_add_u32 v240, v240, v241
    s_lshl_b32 s56, s51, 4
    s_lshl_b32 s57, s98, 3
    s_add_u32 s56, s56, s57
    s_mul_i32 s56, s56, 20480
    s_add_u32 s101, s56, 10682368
    s_add_u32 s57, s101, 0
    s_add_u32 s58, s101, 10240
    buffer_store_dwordx4 v[208:211], v240, s[12:15], s57 offen sc1
    buffer_store_dwordx4 v[216:219], v240, s[12:15], s58 offen sc1
    s_add_u32 s57, s101, 20480
    s_add_u32 s58, s101, 30720
    buffer_store_dwordx4 v[212:215], v240, s[12:15], s57 offen sc1
    buffer_store_dwordx4 v[220:223], v240, s[12:15], s58 offen sc1
    s_nop 1
    v_fma_f32 v160, v192, v143, v160
    v_fma_f32 v176, v192, v159, v176
    v_fma_f32 v160, -v193, v159, v160
    v_fma_f32 v176, v193, v143, v176
    v_fma_f32 v161, v192, v160, v161
    v_fma_f32 v177, v192, v176, v177
    v_fma_f32 v161, -v193, v176, v161
    v_fma_f32 v177, v193, v160, v177
    v_fma_f32 v162, v192, v161, v162
    v_fma_f32 v178, v192, v177, v178
    v_fma_f32 v162, -v193, v177, v162
    v_fma_f32 v178, v193, v161, v178
    v_fma_f32 v163, v192, v162, v163
    v_fma_f32 v179, v192, v178, v179
    v_fma_f32 v163, -v193, v178, v163
    v_fma_f32 v179, v193, v162, v179
    v_fma_f32 v164, v192, v163, v164
    v_fma_f32 v180, v192, v179, v180
    v_fma_f32 v164, -v193, v179, v164
    v_fma_f32 v180, v193, v163, v180
    v_fma_f32 v165, v192, v164, v165
    v_fma_f32 v181, v192, v180, v181
    v_fma_f32 v165, -v193, v180, v165
    v_fma_f32 v181, v193, v164, v181
    v_fma_f32 v166, v192, v165, v166
    v_fma_f32 v182, v192, v181, v182
    v_fma_f32 v166, -v193, v181, v166
    v_fma_f32 v182, v193, v165, v182
    v_fma_f32 v167, v192, v166, v167
    v_fma_f32 v183, v192, v182, v183
    v_fma_f32 v167, -v193, v182, v167
    v_fma_f32 v183, v193, v166, v183
    v_fma_f32 v168, v192, v167, v168
    v_fma_f32 v184, v192, v183, v184
    v_fma_f32 v168, -v193, v183, v168
    v_fma_f32 v184, v193, v167, v184
    v_fma_f32 v169, v192, v168, v169
    v_fma_f32 v185, v192, v184, v185
    v_fma_f32 v169, -v193, v184, v169
    v_fma_f32 v185, v193, v168, v185
    v_fma_f32 v170, v192, v169, v170
    v_fma_f32 v186, v192, v185, v186
    v_fma_f32 v170, -v193, v185, v170
    v_fma_f32 v186, v193, v169, v186
    v_fma_f32 v171, v192, v170, v171
    v_fma_f32 v187, v192, v186, v187
    v_fma_f32 v171, -v193, v186, v171
    v_fma_f32 v187, v193, v170, v187
    v_fma_f32 v172, v192, v171, v172
    v_fma_f32 v188, v192, v187, v188
    v_fma_f32 v172, -v193, v187, v172
    v_fma_f32 v188, v193, v171, v188
    v_fma_f32 v173, v192, v172, v173
    v_fma_f32 v189, v192, v188, v189
    v_fma_f32 v173, -v193, v188, v173
    v_fma_f32 v189, v193, v172, v189
    v_fma_f32 v174, v192, v173, v174
    v_fma_f32 v190, v192, v189, v190
    v_fma_f32 v174, -v193, v189, v174
    v_fma_f32 v190, v193, v173, v190
    v_fma_f32 v175, v192, v174, v175
    v_fma_f32 v191, v192, v190, v191
    v_fma_f32 v175, -v193, v190, v175
    v_fma_f32 v191, v193, v174, v191
    v_pk_mul_f32 v[116:117], v[176:177], v[198:199] op_sel:[0,1] op_sel_hi:[1,1]
    v_pk_mul_f32 v[118:119], v[176:177], v[198:199] op_sel_hi:[1,0]
    v_pk_fma_f32 v[116:117], v[160:161], v[198:199], v[116:117] op_sel_hi:[1,0,1] neg_lo:[0,0,1] neg_hi:[0,0,1]
    v_pk_fma_f32 v[118:119], v[160:161], v[198:199], v[118:119] op_sel:[0,1,0] op_sel_hi:[1,1,1]
    v_cvt_pk_bf16_f32 v208, v116, v117
    v_cvt_pk_bf16_f32 v216, -v118, -v119
    v_pk_mul_f32 v[120:121], v[178:179], v[198:199] op_sel:[0,1] op_sel_hi:[1,1]
    v_pk_mul_f32 v[122:123], v[178:179], v[198:199] op_sel_hi:[1,0]
    v_pk_fma_f32 v[120:121], v[162:163], v[198:199], v[120:121] op_sel_hi:[1,0,1] neg_lo:[0,0,1] neg_hi:[0,0,1]
    v_pk_fma_f32 v[122:123], v[162:163], v[198:199], v[122:123] op_sel:[0,1,0] op_sel_hi:[1,1,1]
    v_cvt_pk_bf16_f32 v209, v120, v121
    v_cvt_pk_bf16_f32 v217, -v122, -v123
    v_pk_mul_f32 v[116:117], v[180:181], v[198:199] op_sel:[0,1] op_sel_hi:[1,1]
    v_pk_mul_f32 v[118:119], v[180:181], v[198:199] op_sel_hi:[1,0]
    v_pk_fma_f32 v[116:117], v[164:165], v[198:199], v[116:117] op_sel_hi:[1,0,1] neg_lo:[0,0,1] neg_hi:[0,0,1]
    v_pk_fma_f32 v[118:119], v[164:165], v[198:199], v[118:119] op_sel:[0,1,0] op_sel_hi:[1,1,1]
    v_cvt_pk_bf16_f32 v210, v116, v117
    v_cvt_pk_bf16_f32 v218, -v118, -v119
    v_pk_mul_f32 v[120:121], v[182:183], v[198:199] op_sel:[0,1] op_sel_hi:[1,1]
    v_pk_mul_f32 v[122:123], v[182:183], v[198:199] op_sel_hi:[1,0]
    v_pk_fma_f32 v[120:121], v[166:167], v[198:199], v[120:121] op_sel_hi:[1,0,1] neg_lo:[0,0,1] neg_hi:[0,0,1]
    v_pk_fma_f32 v[122:123], v[166:167], v[198:199], v[122:123] op_sel:[0,1,0] op_sel_hi:[1,1,1]
    v_cvt_pk_bf16_f32 v211, v120, v121
    v_cvt_pk_bf16_f32 v219, -v122, -v123
    v_pk_mul_f32 v[116:117], v[184:185], v[198:199] op_sel:[0,1] op_sel_hi:[1,1]
    v_pk_mul_f32 v[118:119], v[184:185], v[198:199] op_sel_hi:[1,0]
    v_pk_fma_f32 v[116:117], v[168:169], v[198:199], v[116:117] op_sel_hi:[1,0,1] neg_lo:[0,0,1] neg_hi:[0,0,1]
    v_pk_fma_f32 v[118:119], v[168:169], v[198:199], v[118:119] op_sel:[0,1,0] op_sel_hi:[1,1,1]
    v_cvt_pk_bf16_f32 v212, v116, v117
    v_cvt_pk_bf16_f32 v220, -v118, -v119
    v_pk_mul_f32 v[120:121], v[186:187], v[198:199] op_sel:[0,1] op_sel_hi:[1,1]
    v_pk_mul_f32 v[122:123], v[186:187], v[198:199] op_sel_hi:[1,0]
    v_pk_fma_f32 v[120:121], v[170:171], v[198:199], v[120:121] op_sel_hi:[1,0,1] neg_lo:[0,0,1] neg_hi:[0,0,1]
    v_pk_fma_f32 v[122:123], v[170:171], v[198:199], v[122:123] op_sel:[0,1,0] op_sel_hi:[1,1,1]
    v_cvt_pk_bf16_f32 v213, v120, v121
    v_cvt_pk_bf16_f32 v221, -v122, -v123
    v_pk_mul_f32 v[116:117], v[188:189], v[198:199] op_sel:[0,1] op_sel_hi:[1,1]
    v_pk_mul_f32 v[118:119], v[188:189], v[198:199] op_sel_hi:[1,0]
    v_pk_fma_f32 v[116:117], v[172:173], v[198:199], v[116:117] op_sel_hi:[1,0,1] neg_lo:[0,0,1] neg_hi:[0,0,1]
    v_pk_fma_f32 v[118:119], v[172:173], v[198:199], v[118:119] op_sel:[0,1,0] op_sel_hi:[1,1,1]
    v_cvt_pk_bf16_f32 v214, v116, v117
    v_cvt_pk_bf16_f32 v222, -v118, -v119
    v_pk_mul_f32 v[120:121], v[190:191], v[198:199] op_sel:[0,1] op_sel_hi:[1,1]
    v_pk_mul_f32 v[122:123], v[190:191], v[198:199] op_sel_hi:[1,0]
    v_pk_fma_f32 v[120:121], v[174:175], v[198:199], v[120:121] op_sel_hi:[1,0,1] neg_lo:[0,0,1] neg_hi:[0,0,1]
    v_pk_fma_f32 v[122:123], v[174:175], v[198:199], v[122:123] op_sel:[0,1,0] op_sel_hi:[1,1,1]
    v_cvt_pk_bf16_f32 v215, v120, v121
    v_cvt_pk_bf16_f32 v223, -v122, -v123
    s_add_u32 s57, s101, 40960
    s_add_u32 s58, s101, 51200
    buffer_store_dwordx4 v[208:211], v240, s[12:15], s57 offen sc1
    buffer_store_dwordx4 v[216:219], v240, s[12:15], s58 offen sc1
    s_add_u32 s57, s101, 61440
    s_add_u32 s58, s101, 71680
    buffer_store_dwordx4 v[212:215], v240, s[12:15], s57 offen sc1
    buffer_store_dwordx4 v[220:223], v240, s[12:15], s58 offen sc1
    s_branch A_HOOKRET
HK_FLAGH:
    s_lshl_b32 s56, s51, 8
    s_lshl_b32 s57, s52, 4
    s_add_u32 s56, s56, s57
    s_lshl_b32 s57, s38, 2
    s_add_u32 s56, s56, s57
    s_add_u32 s56, s56, 16121856
    v_mov_b32 v240, 0
    v_mov_b32 v241, s55
    s_mov_b64 exec, 1
    buffer_store_dword v241, v240, s[12:15], s56 offen sc1
    s_mov_b64 exec, -1
    s_branch A_HOOKRET
HK_WO:
    s_cmp_eq_u32 s71, 4
    s_cbranch_scc1 HK_WO1
    s_cmp_eq_u32 s71, 5
    s_cbranch_scc1 HK_WO2
    s_add_u32 m0, s101, 0
    s_add_u32 s56, s99, 0
    buffer_load_dwordx4 v230, s[28:31], s56 offen lds
    s_add_u32 m0, s101, 1024
    s_add_u32 s56, s99, 10240
    buffer_load_dwordx4 v230, s[28:31], s56 offen lds
    s_add_u32 m0, s101, 2048
    s_add_u32 s56, s99, 20480
    buffer_load_dwordx4 v231, s[28:31], s56 offen lds
    s_add_u32 m0, s101, 3072
    s_add_u32 s56, s99, 25600
    buffer_load_dwordx4 v230, s[28:31], s56 offen lds
    s_add_u32 m0, s101, 4096
    s_add_u32 s56, s99, 35840
    buffer_load_dwordx4 v230, s[28:31], s56 offen lds
    s_add_u32 m0, s101, 5120
    s_add_u32 s56, s99, 51200
    buffer_load_dwordx4 v230, s[28:31], s56 offen lds
    s_add_u32 m0, s101, 6144
    s_add_u32 s56, s99, 61440
    buffer_load_dwordx4 v230, s[28:31], s56 offen lds
    s_branch A_HOOKRET
HK_WO1:
    s_add_u32 m0, s101, 7168
    s_add_u32 s56, s99, 71680
    buffer_load_dwordx4 v231, s[28:31], s56 offen lds
    s_add_u32 m0, s101, 8192
    s_add_u32 s56, s99, 76800
    buffer_load_dwordx4 v230, s[28:31], s56 offen lds
    s_add_u32 m0, s101, 9216
    s_add_u32 s56, s99, 87040
    buffer_load_dwordx4 v230, s[28:31], s56 offen lds
    s_add_u32 m0, s101, 10240
    s_add_u32 s56, s99, 102400
    buffer_load_dwordx4 v230, s[28:31], s56 offen lds
    s_add_u32 m0, s101, 11264
    s_add_u32 s56, s99, 112640
    buffer_load_dwordx4 v230, s[28:31], s56 offen lds
    s_add_u32 m0, s101, 12288
    s_add_u32 s56, s99, 122880
    buffer_load_dwordx4 v231, s[28:31], s56 offen lds
    s_branch A_HOOKRET
HK_WO2:
    s_add_u32 m0, s101, 13312
    s_add_u32 s56, s99, 128000
    buffer_load_dwordx4 v230, s[28:31], s56 offen lds
    s_add_u32 m0, s101, 14336
    s_add_u32 s56, s99, 138240
    buffer_load_dwordx4 v230, s[28:31], s56 offen lds
    s_add_u32 m0, s101, 15360
    s_add_u32 s56, s99, 153600
    buffer_load_dwordx4 v230, s[28:31], s56 offen lds
    s_add_u32 m0, s101, 16384
    s_add_u32 s56, s99, 163840
    buffer_load_dwordx4 v230, s[28:31], s56 offen lds
    s_add_u32 m0, s101, 17408
    s_add_u32 s56, s99, 174080
    buffer_load_dwordx4 v231, s[28:31], s56 offen lds
    s_add_u32 m0, s101, 18432
    s_add_u32 s56, s99, 179200
    buffer_load_dwordx4 v230, s[28:31], s56 offen lds
    s_add_u32 m0, s101, 19456
    s_add_u32 s56, s99, 189440
    buffer_load_dwordx4 v230, s[28:31], s56 offen lds
    s_branch A_HOOKRET
HK_WS:
    v_bfe_u32 v224, v1, 4, 1
    v_bfe_u32 v225, v1, 1, 1
    v_lshl_add_u32 v224, v224, 1, v225
    v_bfe_u32 v225, v1, 3, 1
    v_lshlrev_b32 v225, 2, v225
    v_xor_b32 v224, v224, v225
    v_bfe_u32 v225, v1, 2, 2
    v_lshl_add_u32 v225, v15, 3, v225
    v_lshlrev_b32 v225, 7, v225
    v_lshl_add_u32 v224, v224, 4, v225
    v_and_b32 v225, 1, v1
    v_lshl_add_u32 v224, v225, 3, v224
    v_add_u32 v224, 45056, v224
    v_xor_b32 v225, 64, v224
    s_and_b32 s56, s38, 3
    s_lshl_b32 s56, s56, 13
    s_lshr_b32 s57, s38, 2
    s_mul_i32 s58, s57, 126976
    s_add_u32 s58, s58, s56
    v_lshl_add_u32 v226, v14, 2, s58
    v_lshl_add_u32 v226, v15, 10, v226
    s_lshl_b32 s57, s57, 12
    s_add_u32 s56, s56, s57
    v_add_u32 v228, s56, v248
    v_add_u32 v229, 126976, v228
    v_lshrrev_b32 v227, 4, v1
    v_mul_u32_u24 v227, 5120, v227
    v_and_b32 v242, 0xf0, v248
    v_add_u32 v227, v227, v242
    s_branch A_HOOKRET
HK_CWG:
    s_cmp_ge_u32 s48, 30
    s_cbranch_scc1 HK_N
    s_cmp_lt_u32 s71, 3
    s_cbranch_scc1 HK_CC
    s_cmp_eq_u32 s71, 6
    s_cbranch_scc1 HK_C
    s_cmp_eq_u32 s71, 7
    s_cbranch_scc1 HK_C3
HK_CW:
    s_add_u32 s57, s43, 8192
    s_bitcmp1_b32 s51, 0
    s_cbranch_scc1 HK_CWB
    buffer_load_dword v255, v242, s[20:23], s43 offen
    buffer_load_dword v255, v242, s[20:23], s57 offen
    s_add_u32 s43, s43, 12288
    s_branch A_HOOKRET
HK_CWB:
    buffer_load_dword v255, v242, s[24:27], s43 offen
    buffer_load_dword v255, v242, s[24:27], s57 offen
    s_add_u32 s43, s43, 12288
    s_branch A_HOOKRET
HK_CW0:
    buffer_load_dword v255, v240, s[20:23], s57 offen
    s_branch A_HOOKRET
HK_CW1:
    buffer_load_dword v255, v240, s[24:27], s57 offen
    s_branch A_HOOKRET
HK_N:
    s_cmp_gt_u32 s71, 2
    s_cbranch_scc1 HK_NC
    s_lshl_b32 s57, s39, 1
    s_add_u32 s57, s57, s48
    s_sub_u32 s57, s57, 30
    s_lshl_b32 s57, s57, 3
    s_add_u32 s57, s57, s38
    s_mul_i32 s57, s57, 6400
    v_lshlrev_b32 v240, 7, v1
    s_cmp_eq_u32 s71, 1
    s_cbranch_scc1 HK_CW1
    s_cmp_eq_u32 s71, 0
    s_cbranch_scc1 HK_CW0
    buffer_load_dword v255, v240, s[28:31], s57 offen
    s_branch A_HOOKRET
HK_NC:
    s_lshl_b32 s57, s38, 13
    v_lshl_add_u32 v240, v1, 7, s57
    v_min_u32 v240, PK_END-PK_BEGIN, v240
    global_load_dword v255, v240, s[92:93]
    s_branch A_HOOKRET
C_PRE:
    s_lshl_b32 s56, s51, 7
    s_lshl_b32 s57, s98, 6
    s_add_u32 s40, s56, s57
    s_lshl_b32 s56, s52, 7
    s_lshl_b32 s57, s99, 6
    s_add_u32 s41, s56, s57
    v_add_u32 v240, s41, v14
    v_lshlrev_b32 v240, 1, v240
    global_load_ushort v237, v240, s[46:47]
    global_load_ushort v238, v240, s[46:47] offset:64
    v_mul_u32_u24 v240, 1280, v14
    v_lshl_add_u32 v240, v15, 4, v240
    s_mul_i32 s42, s40, 1280
    s_lshl_b32 s57, s41, 1
    s_add_u32 s42, s42, s57
    s_add_u32 s43, s42, 40960
    v_bfe_u32 v241, v1, 4, 1
    v_bfe_u32 v242, v1, 1, 1
    v_lshl_add_u32 v241, v241, 1, v242
    s_lshl_b32 s56, s98, 3
    v_add_u32 v241, s56, v241
    v_mul_u32_u24 v241, 1088, v241
    v_bfe_u32 v242, v1, 2, 2
    v_lshl_add_u32 v242, v15, 3, v242
    v_lshl_add_u32 v241, v242, 4, v241
    v_and_b32 v242, 1, v1
    v_lshl_add_u32 v233, v242, 3, v241
    v_bfe_u32 v242, v1, 1, 3
    v_xor_b32 v242, v242, v15
    v_lshlrev_b32 v242, 4, v242
    v_lshl_add_u32 v241, v14, 7, v242
    s_lshl_b32 s56, s99, 13
    s_add_u32 s56, s56, 17408
    v_add_u32 v229, s56, v241
    v_xor_b32 v230, 32, v229
    v_xor_b32 v231, 64, v229
    v_xor_b32 v232, 96, v229
    s_mov_b32 s54, 45056
    v_add_u32 v224, s54, v229
    v_add_u32 v225, s54, v230
    v_add_u32 v226, s54, v231
    v_add_u32 v227, s54, v232
    v_add_u32 v228, s54, v233
    s_lshl_b32 s56, s38, 14
    s_add_u32 s56, s56, 45056
    v_lshl_add_u32 v234, v14, 2, s56
    v_lshl_add_u32 v234, v15, 10, v234
    v_add_u32 v236, s56, v248
    v_lshrrev_b32 v235, 4, v1
    v_mul_u32_u24 v235, 5120, v235
    v_and_b32 v242, 0xf0, v248
    v_add_u32 v235, v235, v242
    s_waitcnt vmcnt(0)
    s_branch HK_CSKIP
HK_C:
    buffer_load_dword v241, v122, s[12:15], s44 offen sc1
    s_branch A_HOOKRET
HK_C2:
    s_waitcnt vmcnt(0)
    v_cmp_ne_u32 vcc, s55, v241
    s_cbranch_vccz HK_CP_OK
    s_mov_b32 s97, 32768
HK_CP:
    buffer_load_dword v241, v122, s[12:15], s44 offen sc1
    s_waitcnt vmcnt(0)
    v_cmp_ne_u32 vcc, s55, v241
    s_cbranch_vccz HK_CP_OK
    s_sleep 8
    s_sub_u32 s97, s97, 1
    s_cmp_lg_u32 s97, 0
    s_cbranch_scc1 HK_CP
HK_CP_OK:
    s_add_u32 m0, s90, 45056
    s_add_u32 s56, s88, 0
    buffer_load_dwordx4 v248, s[12:15], s56 offen sc1 lds
    s_add_u32 m0, s90, 46144
    s_add_u32 s56, s88, 20480
    buffer_load_dwordx4 v248, s[12:15], s56 offen sc1 lds
    s_add_u32 m0, s90, 47232
    s_add_u32 s56, s88, 40960
    buffer_load_dwordx4 v248, s[12:15], s56 offen sc1 lds
    s_add_u32 m0, s90, 48320
    s_add_u32 s56, s88, 61440
    buffer_load_dwordx4 v248, s[12:15], s56 offen sc1 lds
    s_add_u32 m0, s91, 62464
    s_add_u32 s56, s89, 0
    buffer_load_dwordx4 v120, s[20:23], s56 offen lds
    s_add_u32 m0, s91, 63488
    s_add_u32 s56, s89, 10240
    buffer_load_dwordx4 v121, s[20:23], s56 offen lds
    s_add_u32 m0, s91, 64512
    s_add_u32 s56, s89, 20480
    buffer_load_dwordx4 v120, s[20:23], s56 offen lds
    s_add_u32 m0, s91, 65536
    s_add_u32 s56, s89, 30720
    buffer_load_dwordx4 v121, s[20:23], s56 offen lds
    buffer_load_dword v255, v242, s[12:15], s45 offen sc1
    s_add_u32 s56, s45, 8192
    buffer_load_dword v255, v242, s[12:15], s56 offen sc1
    s_branch A_HOOKBRET
HK_C3:
    s_add_u32 m0, s90, 78848
    s_add_u32 s56, s88, 1024
    buffer_load_dwordx4 v248, s[12:15], s56 offen sc1 lds
    s_add_u32 m0, s90, 79936
    s_add_u32 s56, s88, 21504
    buffer_load_dwordx4 v248, s[12:15], s56 offen sc1 lds
    s_add_u32 m0, s90, 81024
    s_add_u32 s56, s88, 41984
    buffer_load_dwordx4 v248, s[12:15], s56 offen sc1 lds
    s_add_u32 m0, s90, 82112
    s_add_u32 s56, s88, 62464
    buffer_load_dwordx4 v248, s[12:15], s56 offen sc1 lds
    s_add_u32 m0, s91, 96256
    s_add_u32 s56, s89, 128
    buffer_load_dwordx4 v120, s[20:23], s56 offen lds
    s_add_u32 m0, s91, 97280
    s_add_u32 s56, s89, 10368
    buffer_load_dwordx4 v121, s[20:23], s56 offen lds
    s_add_u32 m0, s91, 98304
    s_add_u32 s56, s89, 20608
    buffer_load_dwordx4 v120, s[20:23], s56 offen lds
    s_add_u32 m0, s91, 99328
    s_add_u32 s56, s89, 30848
    buffer_load_dwordx4 v121, s[20:23], s56 offen lds
    s_branch A_HOOKRET
HK_R4:
    s_add_u32 m0, s101, 112640
    s_add_u32 s56, s99, 2048
    buffer_load_dwordx4 v248, s[12:15], s56 offen sc1 lds
    s_add_u32 m0, s101, 113728
    s_add_u32 s56, s99, 22528
    buffer_load_dwordx4 v248, s[12:15], s56 offen sc1 lds
    s_add_u32 m0, s101, 114816
    s_add_u32 s56, s99, 43008
    buffer_load_dwordx4 v248, s[12:15], s56 offen sc1 lds
    s_add_u32 m0, s101, 115904
    s_add_u32 s56, s99, 63488
    buffer_load_dwordx4 v248, s[12:15], s56 offen sc1 lds
    s_add_u32 m0, s3, 130048
    s_add_u32 s56, s100, 256
    buffer_load_dwordx4 v234, s[20:23], s56 offen lds
    s_add_u32 m0, s3, 131072
    s_add_u32 s56, s100, 10496
    buffer_load_dwordx4 v235, s[20:23], s56 offen lds
    s_add_u32 m0, s3, 132096
    s_add_u32 s56, s100, 20736
    buffer_load_dwordx4 v234, s[20:23], s56 offen lds
    s_add_u32 m0, s3, 133120
    s_add_u32 s56, s100, 30976
    buffer_load_dwordx4 v235, s[20:23], s56 offen lds
    s_branch A_HOOKBRET
HK_CSKIP:
    v_and_b32 v242, 1, v14
    v_lshlrev_b32 v242, 4, v242
    v_lshlrev_b32 v237, v242, v237
    v_lshlrev_b32 v238, v242, v238
    v_lshlrev_b32 v242, 3, v15
    v_sub_u32 v242, v14, v242
    v_ashrrev_i32 v242, 1, v242
    v_cmp_eq_u32 vcc, 0, v242
    s_nop 1
    v_cndmask_b32 v52, 0, v237, vcc
    v_cndmask_b32 v60, 0, v238, vcc
    v_cmp_eq_u32 vcc, 1, v242
    s_nop 1
    v_cndmask_b32 v53, 0, v237, vcc
    v_cndmask_b32 v61, 0, v238, vcc
    v_cmp_eq_u32 vcc, 2, v242
    s_nop 1
    v_cndmask_b32 v54, 0, v237, vcc
    v_cndmask_b32 v62, 0, v238, vcc
    v_cmp_eq_u32 vcc, 3, v242
    s_nop 1
    v_cndmask_b32 v55, 0, v237, vcc
    v_cndmask_b32 v63, 0, v238, vcc
    v_cmp_eq_u32 vcc, 8, v242
    s_nop 1
    v_cndmask_b32 v56, 0, v237, vcc
    v_cndmask_b32 v116, 0, v238, vcc
    v_cmp_eq_u32 vcc, 9, v242
    s_nop 1
    v_cndmask_b32 v57, 0, v237, vcc
    v_cndmask_b32 v117, 0, v238, vcc
    v_cmp_eq_u32 vcc, 10, v242
    s_nop 1
    v_cndmask_b32 v58, 0, v237, vcc
    v_cndmask_b32 v118, 0, v238, vcc
    v_cmp_eq_u32 vcc, 11, v242
    s_nop 1
    v_cndmask_b32 v59, 0, v237, vcc
    v_cndmask_b32 v119, 0, v238, vcc
    v_lshrrev_b32 v2, 4, v1
    v_and_b32 v3, 7, v1
    v_xor_b32 v3, v3, v2
    v_lshlrev_b32 v3, 4, v3
    v_lshrrev_b32 v2, 3, v1
    v_mul_u32_u24 v2, 1280, v2
    v_add_u32 v120, v2, v3
    v_xor_b32 v121, 64, v120
    v_min_u32 v122, 39, v1
    v_lshlrev_b32 v122, 2, v122
    v_lshlrev_b32 v242, 7, v1
    s_lshl_b32 s44, s51, 8
    s_add_u32 s44, s44, 16121856
    s_mul_i32 s56, s51, 327680
    s_add_u32 s56, s56, 10682368
    s_mul_i32 s57, s52, 163840
    s_mul_i32 s88, s38, 81920
    s_add_u32 s88, s88, s56
    s_mul_i32 s89, s38, 40960
    s_add_u32 s89, s89, s57
    s_mul_i32 s90, s38, 4352
    s_lshl_b32 s91, s38, 12
    s_lshl_b32 s45, s52, 16
    s_add_u32 s45, s45, s56
    s_lshl_b32 s57, s38, 14
    s_add_u32 s45, s45, s57
    s_branch C_ATT2
HK_CC:
    s_cmp_eq_u32 s71, 2
    s_cbranch_scc1 HK_CM
    buffer_load_dwordx4 v[192:195], v240, s[16:19], s42 offen offset:0
    buffer_load_dwordx4 v[196:199], v240, s[16:19], s42 offen offset:32
    buffer_load_dwordx4 v[200:203], v240, s[16:19], s42 offen offset:64
    buffer_load_dwordx4 v[204:207], v240, s[16:19], s42 offen offset:96
    buffer_load_dwordx4 v[208:211], v240, s[16:19], s43 offen offset:0
    buffer_load_dwordx4 v[212:215], v240, s[16:19], s43 offen offset:32
    buffer_load_dwordx4 v[216:219], v240, s[16:19], s43 offen offset:64
    buffer_load_dwordx4 v[220:223], v240, s[16:19], s43 offen offset:96
    s_branch A_HOOKRET
HK_CM:
    v_mfma_f32_32x32x16_bf16 v[128:143], v[192:195], v[52:55], 0
    v_mfma_f32_32x32x16_bf16 v[144:159], v[200:203], v[60:63], 0
    v_mfma_f32_32x32x16_bf16 v[160:175], v[208:211], v[52:55], 0
    v_mfma_f32_32x32x16_bf16 v[176:191], v[216:219], v[60:63], 0
    v_mfma_f32_32x32x16_bf16 v[128:143], v[196:199], v[56:59], v[128:143]
    v_mfma_f32_32x32x16_bf16 v[144:159], v[204:207], v[116:119], v[144:159]
    v_mfma_f32_32x32x16_bf16 v[160:175], v[212:215], v[56:59], v[160:175]
    v_mov_b32 v208, 0
    v_mov_b32 v209, 0
    v_mov_b32 v210, 0
    v_mov_b32 v211, 0
    v_mov_b32 v212, 0
    v_mov_b32 v213, 0
    v_mov_b32 v214, 0
    v_mov_b32 v215, 0
    v_mfma_f32_32x32x16_bf16 v[176:191], v[220:223], v[116:119], v[176:191]
    v_mov_b32 v216, 0
    v_mov_b32 v217, 0
    v_mov_b32 v218, 0
    v_mov_b32 v219, 0
    v_mov_b32 v220, 0
    v_mov_b32 v221, 0
    v_mov_b32 v222, 0
    v_mov_b32 v223, 0
    s_branch A_HOOKRET
W_PHASE:
    s_cmp_lg_u32 s38, 4
    s_cbranch_scc1 W_NF
    v_lshlrev_b32 v6, 10, v1
    v_mov_b32 v7, s55
    s_mov_b64 exec, 15
    buffer_store_dword v7, v6, s[12:15], s75 offen sc1
    s_mov_b64 exec, -1
W_NF:
    s_and_b32 s58, s38, 3
    s_lshr_b32 s59, s38, 2
    s_lshl_b32 s10, s51, 7
    s_lshl_b32 s56, s58, 5
    s_add_u32 s10, s10, s56
    s_lshl_b32 s11, s10, 4
    s_add_u32 s11, s11, 7995392
    s_lshl_b32 s56, s59, 4
    s_add_u32 s10, s10, s56
    s_mul_i32 s10, s10, 5120
    s_lshl_b32 s56, s52, 8
    s_add_u32 s10, s10, s56
    s_lshr_b32 s57, s48, 2
    s_mul_i32 s59, s59, 5
    s_add_u32 s40, s57, s59
    s_add_u32 s57, s57, 1
    s_cmp_eq_u32 s57, 5
    s_cselect_b32 s57, 0, s57
    s_add_u32 s41, s57, s59
    s_add_u32 s57, s57, 1
    s_cmp_eq_u32 s57, 5
    s_cselect_b32 s57, 0, s57
    s_add_u32 s42, s57, s59
    s_add_u32 s57, s57, 1
    s_cmp_eq_u32 s57, 5
    s_cselect_b32 s57, 0, s57
    s_add_u32 s43, s57, s59
    s_add_u32 s57, s57, 1
    s_cmp_eq_u32 s57, 5
    s_cselect_b32 s57, 0, s57
    s_add_u32 s44, s57, s59
    s_add_u32 s57, s57, 1
    s_cmp_eq_u32 s57, 5
    s_cselect_b32 s57, 0, s57
    s_lshl_b32 s56, s40, 13
    v_add_u32 v8, s56, v224
    v_add_u32 v9, s56, v225
    v_add_u32 v2, 128, v226
    ds_read_b64_tr_b16 v[48:49], v8 offset:0
    ds_read_b64_tr_b16 v[50:51], v8 offset:512
    ds_read_b64_tr_b16 v[52:53], v9 offset:0
    ds_read_b64_tr_b16 v[54:55], v9 offset:512
    ds_read_b64_tr_b16 v[56:57], v8 offset:2048
    ds_read_b64_tr_b16 v[58:59], v8 offset:2560
    ds_read_b64_tr_b16 v[60:61], v9 offset:2048
    ds_read_b64_tr_b16 v[62:63], v9 offset:2560
    s_cmp_lg_u32 s38, 4
    s_cbranch_scc1 W_BAR
    s_lshr_b32 s96, s51, 1
    s_lshl_b32 s96, s96, 7
    s_and_b32 s56, s52, 3
    s_lshl_b32 s56, s56, 10
    s_add_u32 s96, s96, s56
    s_add_u32 s96, s96, 16138240
    v_lshlrev_b32 v6, 2, v14
    s_mov_b32 s97, 32768
W_PO:
    buffer_load_dword v7, v6, s[12:15], s96 offen sc1
    s_waitcnt vmcnt(0)
    v_cmp_ne_u32 vcc, s55, v7
    s_cbranch_vccz W_PO_OK
    s_sleep 4
    s_sub_u32 s97, s97, 1
    s_cmp_lg_u32 s97, 0
    s_cbranch_scc1 W_PO
W_PO_OK:
W_BAR:
    s_barrier
    s_mul_i32 s57, s40, 267264
    s_add_u32 s57, s57, s11
    buffer_load_dwordx4 v[64:67], v254, s[12:15], s57 offen sc1
    s_add_u32 s57, s57, 66816
    buffer_load_dwordx4 v[68:71], v254, s[12:15], s57 offen sc1
    s_add_u32 s57, s57, 66816
    buffer_load_dwordx4 v[72:75], v254, s[12:15], s57 offen sc1
    s_add_u32 s57, s57, 66816
    buffer_load_dwordx4 v[76:79], v254, s[12:15], s57 offen sc1
    s_mul_i32 s57, s41, 267264
    s_add_u32 s57, s57, s11
    buffer_load_dwordx4 v[80:83], v254, s[12:15], s57 offen sc1
    s_add_u32 s57, s57, 66816
    buffer_load_dwordx4 v[84:87], v254, s[12:15], s57 offen sc1
    s_waitcnt vmcnt(5) lgkmcnt(4)
    v_mfma_f32_32x32x16_bf16 v[16:31], v[64:67], v[48:51], 0
    ds_read_b64_tr_b16 v[232:233], v8 offset:4096
    ds_read_b64_tr_b16 v[234:235], v8 offset:4608
    ds_read_b64_tr_b16 v[236:237], v9 offset:4096
    ds_read_b64_tr_b16 v[238:239], v9 offset:4608
    v_mfma_f32_32x32x16_bf16 v[32:47], v[64:67], v[52:55], 0
    s_add_u32 s57, s57, 66816
    buffer_load_dwordx4 v[88:91], v254, s[12:15], s57 offen sc1
    s_lshl_b32 s56, s41, 13
    v_add_u32 v10, s56, v224
    v_add_u32 v11, s56, v225
    s_waitcnt vmcnt(5) lgkmcnt(4)
    v_mfma_f32_32x32x16_bf16 v[16:31], v[68:71], v[56:59], v[16:31]
    ds_read_b64_tr_b16 v[48:49], v8 offset:6144
    ds_read_b64_tr_b16 v[50:51], v8 offset:6656
    ds_read_b64_tr_b16 v[52:53], v9 offset:6144
    ds_read_b64_tr_b16 v[54:55], v9 offset:6656
    v_mfma_f32_32x32x16_bf16 v[32:47], v[68:71], v[60:63], v[32:47]
    s_add_u32 s57, s57, 66816
    buffer_load_dwordx4 v[92:95], v254, s[12:15], s57 offen sc1
    s_waitcnt vmcnt(5) lgkmcnt(4)
    v_mfma_f32_32x32x16_bf16 v[16:31], v[72:75], v[232:235], v[16:31]
    ds_read_b64_tr_b16 v[56:57], v10 offset:0
    ds_read_b64_tr_b16 v[58:59], v10 offset:512
    ds_read_b64_tr_b16 v[60:61], v11 offset:0
    ds_read_b64_tr_b16 v[62:63], v11 offset:512
    v_mfma_f32_32x32x16_bf16 v[32:47], v[72:75], v[236:239], v[32:47]
    s_mul_i32 s57, s42, 267264
    s_add_u32 s57, s57, s11
    buffer_load_dwordx4 v[96:99], v254, s[12:15], s57 offen sc1
    s_waitcnt vmcnt(5) lgkmcnt(4)
    v_mfma_f32_32x32x16_bf16 v[16:31], v[76:79], v[48:51], v[16:31]
    ds_read_b64_tr_b16 v[232:233], v10 offset:2048
    ds_read_b64_tr_b16 v[234:235], v10 offset:2560
    ds_read_b64_tr_b16 v[236:237], v11 offset:2048
    ds_read_b64_tr_b16 v[238:239], v11 offset:2560
    v_mfma_f32_32x32x16_bf16 v[32:47], v[76:79], v[52:55], v[32:47]
    s_add_u32 s57, s57, 66816
    buffer_load_dwordx4 v[100:103], v254, s[12:15], s57 offen sc1
    s_waitcnt vmcnt(5) lgkmcnt(4)
    v_mfma_f32_32x32x16_bf16 v[16:31], v[80:83], v[56:59], v[16:31]
    ds_read_b64_tr_b16 v[48:49], v10 offset:4096
    ds_read_b64_tr_b16 v[50:51], v10 offset:4608
    ds_read_b64_tr_b16 v[52:53], v11 offset:4096
    ds_read_b64_tr_b16 v[54:55], v11 offset:4608
    v_mfma_f32_32x32x16_bf16 v[32:47], v[80:83], v[60:63], v[32:47]
    s_add_u32 s57, s57, 66816
    buffer_load_dwordx4 v[104:107], v254, s[12:15], s57 offen sc1
    s_lshl_b32 s56, s42, 13
    v_add_u32 v8, s56, v224
    v_add_u32 v9, s56, v225
    s_waitcnt vmcnt(5) lgkmcnt(4)
    v_mfma_f32_32x32x16_bf16 v[16:31], v[84:87], v[232:235], v[16:31]
    ds_read_b64_tr_b16 v[56:57], v10 offset:6144
    ds_read_b64_tr_b16 v[58:59], v10 offset:6656
    ds_read_b64_tr_b16 v[60:61], v11 offset:6144
    ds_read_b64_tr_b16 v[62:63], v11 offset:6656
    v_mfma_f32_32x32x16_bf16 v[32:47], v[84:87], v[236:239], v[32:47]
    s_add_u32 s57, s57, 66816
    buffer_load_dwordx4 v[108:111], v254, s[12:15], s57 offen sc1
    s_waitcnt vmcnt(5) lgkmcnt(4)
    v_mfma_f32_32x32x16_bf16 v[16:31], v[88:91], v[48:51], v[16:31]
    ds_read_b64_tr_b16 v[232:233], v8 offset:0
    ds_read_b64_tr_b16 v[234:235], v8 offset:512
    ds_read_b64_tr_b16 v[236:237], v9 offset:0
    ds_read_b64_tr_b16 v[238:239], v9 offset:512
    v_mfma_f32_32x32x16_bf16 v[32:47], v[88:91], v[52:55], v[32:47]
    s_mul_i32 s57, s43, 267264
    s_add_u32 s57, s57, s11
    buffer_load_dwordx4 v[112:115], v254, s[12:15], s57 offen sc1
    s_waitcnt vmcnt(5) lgkmcnt(4)
    v_mfma_f32_32x32x16_bf16 v[16:31], v[92:95], v[56:59], v[16:31]
    ds_read_b64_tr_b16 v[48:49], v8 offset:2048
    ds_read_b64_tr_b16 v[50:51], v8 offset:2560
    ds_read_b64_tr_b16 v[52:53], v9 offset:2048
    ds_read_b64_tr_b16 v[54:55], v9 offset:2560
    v_mfma_f32_32x32x16_bf16 v[32:47], v[92:95], v[60:63], v[32:47]
    s_add_u32 s57, s57, 66816
    buffer_load_dwordx4 v[116:119], v254, s[12:15], s57 offen sc1
    s_waitcnt vmcnt(5) lgkmcnt(4)
    v_mfma_f32_32x32x16_bf16 v[16:31], v[96:99], v[232:235], v[16:31]
    ds_read_b64_tr_b16 v[56:57], v8 offset:4096
    ds_read_b64_tr_b16 v[58:59], v8 offset:4608
    ds_read_b64_tr_b16 v[60:61], v9 offset:4096
    ds_read_b64_tr_b16 v[62:63], v9 offset:4608
    v_mfma_f32_32x32x16_bf16 v[32:47], v[96:99], v[236:239], v[32:47]
    s_add_u32 s57, s57, 66816
    buffer_load_dwordx4 v[120:123], v254, s[12:15], s57 offen sc1
    s_lshl_b32 s56, s43, 13
    v_add_u32 v10, s56, v224
    v_add_u32 v11, s56, v225
    s_waitcnt vmcnt(5) lgkmcnt(4)
    v_mfma_f32_32x32x16_bf16 v[16:31], v[100:103], v[48:51], v[16:31]
    ds_read_b64_tr_b16 v[232:233], v8 offset:6144
    ds_read_b64_tr_b16 v[234:235], v8 offset:6656
    ds_read_b64_tr_b16 v[236:237], v9 offset:6144
    ds_read_b64_tr_b16 v[238:239], v9 offset:6656
    v_mfma_f32_32x32x16_bf16 v[32:47], v[100:103], v[52:55], v[32:47]
    s_add_u32 s57, s57, 66816
    buffer_load_dwordx4 v[124:127], v254, s[12:15], s57 offen sc1
    s_waitcnt vmcnt(5) lgkmcnt(4)
    v_mfma_f32_32x32x16_bf16 v[16:31], v[104:107], v[56:59], v[16:31]
    ds_read_b64_tr_b16 v[48:49], v10 offset:0
    ds_read_b64_tr_b16 v[50:51], v10 offset:512
    ds_read_b64_tr_b16 v[52:53], v11 offset:0
    ds_read_b64_tr_b16 v[54:55], v11 offset:512
    v_mfma_f32_32x32x16_bf16 v[32:47], v[104:107], v[60:63], v[32:47]
    s_mul_i32 s57, s44, 267264
    s_add_u32 s57, s57, s11
    buffer_load_dwordx4 v[128:131], v254, s[12:15], s57 offen sc1
    s_waitcnt vmcnt(5) lgkmcnt(4)
    v_mfma_f32_32x32x16_bf16 v[16:31], v[108:111], v[232:235], v[16:31]
    ds_read_b64_tr_b16 v[56:57], v10 offset:2048
    ds_read_b64_tr_b16 v[58:59], v10 offset:2560
    ds_read_b64_tr_b16 v[60:61], v11 offset:2048
    ds_read_b64_tr_b16 v[62:63], v11 offset:2560
    v_mfma_f32_32x32x16_bf16 v[32:47], v[108:111], v[236:239], v[32:47]
    s_add_u32 s57, s57, 66816
    buffer_load_dwordx4 v[132:135], v254, s[12:15], s57 offen sc1
    s_waitcnt vmcnt(5) lgkmcnt(4)
    v_mfma_f32_32x32x16_bf16 v[16:31], v[112:115], v[48:51], v[16:31]
    ds_read_b64_tr_b16 v[232:233], v10 offset:4096
    ds_read_b64_tr_b16 v[234:235], v10 offset:4608
    ds_read_b64_tr_b16 v[236:237], v11 offset:4096
    ds_read_b64_tr_b16 v[238:239], v11 offset:4608
    v_mfma_f32_32x32x16_bf16 v[32:47], v[112:115], v[52:55], v[32:47]
    s_add_u32 s57, s57, 66816
    buffer_load_dwordx4 v[136:139], v254, s[12:15], s57 offen sc1
    s_lshl_b32 s56, s44, 13
    v_add_u32 v8, s56, v224
    v_add_u32 v9, s56, v225
    s_waitcnt vmcnt(5) lgkmcnt(4)
    v_mfma_f32_32x32x16_bf16 v[16:31], v[116:119], v[56:59], v[16:31]
    ds_read_b64_tr_b16 v[48:49], v10 offset:6144
    ds_read_b64_tr_b16 v[50:51], v10 offset:6656
    ds_read_b64_tr_b16 v[52:53], v11 offset:6144
    ds_read_b64_tr_b16 v[54:55], v11 offset:6656
    v_mfma_f32_32x32x16_bf16 v[32:47], v[116:119], v[60:63], v[32:47]
    s_add_u32 s57, s57, 66816
    buffer_load_dwordx4 v[140:143], v254, s[12:15], s57 offen sc1
    s_waitcnt vmcnt(5) lgkmcnt(4)
    v_mfma_f32_32x32x16_bf16 v[16:31], v[120:123], v[232:235], v[16:31]
    ds_read_b64_tr_b16 v[56:57], v8 offset:0
    ds_read_b64_tr_b16 v[58:59], v8 offset:512
    ds_read_b64_tr_b16 v[60:61], v9 offset:0
    ds_read_b64_tr_b16 v[62:63], v9 offset:512
    v_mfma_f32_32x32x16_bf16 v[32:47], v[120:123], v[236:239], v[32:47]
    s_waitcnt vmcnt(4) lgkmcnt(4)
    v_mfma_f32_32x32x16_bf16 v[16:31], v[124:127], v[48:51], v[16:31]
    ds_read_b64_tr_b16 v[232:233], v8 offset:2048
    ds_read_b64_tr_b16 v[234:235], v8 offset:2560
    ds_read_b64_tr_b16 v[236:237], v9 offset:2048
    ds_read_b64_tr_b16 v[238:239], v9 offset:2560
    v_mfma_f32_32x32x16_bf16 v[32:47], v[124:127], v[52:55], v[32:47]
    s_waitcnt vmcnt(3) lgkmcnt(4)
    v_mfma_f32_32x32x16_bf16 v[16:31], v[128:131], v[56:59], v[16:31]
    ds_read_b64_tr_b16 v[48:49], v8 offset:4096
    ds_read_b64_tr_b16 v[50:51], v8 offset:4608
    ds_read_b64_tr_b16 v[52:53], v9 offset:4096
    ds_read_b64_tr_b16 v[54:55], v9 offset:4608
    v_mfma_f32_32x32x16_bf16 v[32:47], v[128:131], v[60:63], v[32:47]
    s_waitcnt vmcnt(2) lgkmcnt(4)
    v_mfma_f32_32x32x16_bf16 v[16:31], v[132:135], v[232:235], v[16:31]
    ds_read_b64_tr_b16 v[56:57], v8 offset:6144
    ds_read_b64_tr_b16 v[58:59], v8 offset:6656
    ds_read_b64_tr_b16 v[60:61], v9 offset:6144
    ds_read_b64_tr_b16 v[62:63], v9 offset:6656
    v_mfma_f32_32x32x16_bf16 v[32:47], v[132:135], v[236:239], v[32:47]
    s_waitcnt vmcnt(1) lgkmcnt(4)
    v_mfma_f32_32x32x16_bf16 v[16:31], v[136:139], v[48:51], v[16:31]
    v_mfma_f32_32x32x16_bf16 v[32:47], v[136:139], v[52:55], v[32:47]
    s_waitcnt vmcnt(0) lgkmcnt(0)
    v_mfma_f32_32x32x16_bf16 v[16:31], v[140:143], v[56:59], v[16:31]
    v_mfma_f32_32x32x16_bf16 v[32:47], v[140:143], v[60:63], v[32:47]
    s_nop 7
    s_nop 3
    ds_write2st64_b32 v226, v16, v17 offset0:0 offset1:1
    ds_write2st64_b32 v226, v18, v19 offset0:2 offset1:3
    ds_write2st64_b32 v226, v20, v21 offset0:8 offset1:9
    ds_write2st64_b32 v226, v22, v23 offset0:10 offset1:11
    ds_write2st64_b32 v226, v24, v25 offset0:16 offset1:17
    ds_write2st64_b32 v226, v26, v27 offset0:18 offset1:19
    ds_write2st64_b32 v226, v28, v29 offset0:24 offset1:25
    ds_write2st64_b32 v226, v30, v31 offset0:26 offset1:27
    ds_write2st64_b32 v2, v32, v33 offset0:0 offset1:1
    ds_write2st64_b32 v2, v34, v35 offset0:2 offset1:3
    ds_write2st64_b32 v2, v36, v37 offset0:8 offset1:9
    ds_write2st64_b32 v2, v38, v39 offset0:10 offset1:11
    ds_write2st64_b32 v2, v40, v41 offset0:16 offset1:17
    ds_write2st64_b32 v2, v42, v43 offset0:18 offset1:19
    ds_write2st64_b32 v2, v44, v45 offset0:24 offset1:25
    ds_write2st64_b32 v2, v46, v47 offset0:26 offset1:27
    s_waitcnt lgkmcnt(0)
    s_barrier
    ds_read_b128 v[64:67], v228 offset:0
    ds_read_b128 v[68:71], v229 offset:0
    ds_read_b128 v[72:75], v228 offset:1024
    ds_read_b128 v[76:79], v229 offset:1024
    ds_read_b128 v[80:83], v228 offset:2048
    ds_read_b128 v[84:87], v229 offset:2048
    ds_read_b128 v[88:91], v228 offset:3072
    ds_read_b128 v[92:95], v229 offset:3072
    s_waitcnt lgkmcnt(6)
    v_pk_add_f32 v[64:65], v[64:65], v[68:69]
    v_pk_add_f32 v[66:67], v[66:67], v[70:71]
    s_add_u32 s56, s10, 0
    buffer_store_dwordx4 v[64:67], v227, s[32:35], s56 offen nt
    s_waitcnt lgkmcnt(4)
    v_pk_add_f32 v[72:73], v[72:73], v[76:77]
    v_pk_add_f32 v[74:75], v[74:75], v[78:79]
    s_add_u32 s56, s10, 20480
    buffer_store_dwordx4 v[72:75], v227, s[32:35], s56 offen nt
    s_waitcnt lgkmcnt(2)
    v_pk_add_f32 v[80:81], v[80:81], v[84:85]
    v_pk_add_f32 v[82:83], v[82:83], v[86:87]
    s_add_u32 s56, s10, 40960
    buffer_store_dwordx4 v[80:83], v227, s[32:35], s56 offen nt
    s_waitcnt lgkmcnt(0)
    v_pk_add_f32 v[88:89], v[88:89], v[92:93]
    v_pk_add_f32 v[90:91], v[90:91], v[94:95]
    s_add_u32 s56, s10, 61440
    buffer_store_dwordx4 v[88:91], v227, s[32:35], s56 offen nt
    s_branch PK_FIN
C_PHASE:
    s_cmp_lt_u32 s38, 4
    s_cbranch_scc1 CC_COMP
    s_add_u32 m0, s101, 112640
    s_add_u32 s56, s99, 2048
    buffer_load_dwordx4 v248, s[12:15], s56 offen sc1 lds
    s_add_u32 m0, s101, 113728
    s_add_u32 s56, s99, 22528
    buffer_load_dwordx4 v248, s[12:15], s56 offen sc1 lds
    s_add_u32 m0, s101, 114816
    s_add_u32 s56, s99, 43008
    buffer_load_dwordx4 v248, s[12:15], s56 offen sc1 lds
    s_add_u32 m0, s101, 115904
    s_add_u32 s56, s99, 63488
    buffer_load_dwordx4 v248, s[12:15], s56 offen sc1 lds
    s_add_u32 m0, s3, 130048
    s_add_u32 s56, s100, 256
    buffer_load_dwordx4 v234, s[20:23], s56 offen lds
    s_add_u32 m0, s3, 131072
    s_add_u32 s56, s100, 10496
    buffer_load_dwordx4 v235, s[20:23], s56 offen lds
    s_add_u32 m0, s3, 132096
    s_add_u32 s56, s100, 20736
    buffer_load_dwordx4 v234, s[20:23], s56 offen lds
    s_add_u32 m0, s3, 133120
    s_add_u32 s56, s100, 30976
    buffer_load_dwordx4 v235, s[20:23], s56 offen lds
CL_P0:
    s_add_u32 m0, s101, 0
    s_add_u32 s56, s99, 3072
    buffer_load_dwordx4 v248, s[12:15], s56 offen sc1 lds
    s_add_u32 m0, s101, 1088
    s_add_u32 s56, s99, 23552
    buffer_load_dwordx4 v248, s[12:15], s56 offen sc1 lds
    s_add_u32 m0, s101, 2176
    s_add_u32 s56, s99, 44032
    buffer_load_dwordx4 v248, s[12:15], s56 offen sc1 lds
    s_add_u32 m0, s101, 3264
    s_add_u32 s56, s99, 64512
    buffer_load_dwordx4 v248, s[12:15], s56 offen sc1 lds
    s_add_u32 m0, s3, 17408
    s_add_u32 s56, s100, 384
    buffer_load_dwordx4 v234, s[20:23], s56 offen lds
    s_add_u32 m0, s3, 18432
    s_add_u32 s56, s100, 10624
    buffer_load_dwordx4 v235, s[20:23], s56 offen lds
    s_add_u32 m0, s3, 19456
    s_add_u32 s56, s100, 20864
    buffer_load_dwordx4 v234, s[20:23], s56 offen lds
    s_add_u32 m0, s3, 20480
    s_add_u32 s56, s100, 31104
    buffer_load_dwordx4 v235, s[20:23], s56 offen lds
    s_waitcnt vmcnt(8)
    s_barrier
    s_add_u32 m0, s101, 45056
    s_add_u32 s56, s99, 4096
    buffer_load_dwordx4 v248, s[12:15], s56 offen sc1 lds
    s_add_u32 m0, s101, 46144
    s_add_u32 s56, s99, 24576
    buffer_load_dwordx4 v248, s[12:15], s56 offen sc1 lds
    s_add_u32 m0, s101, 47232
    s_add_u32 s56, s99, 45056
    buffer_load_dwordx4 v248, s[12:15], s56 offen sc1 lds
    s_add_u32 m0, s101, 48320
    s_add_u32 s56, s99, 65536
    buffer_load_dwordx4 v248, s[12:15], s56 offen sc1 lds
    s_add_u32 m0, s3, 62464
    s_add_u32 s56, s100, 512
    buffer_load_dwordx4 v234, s[20:23], s56 offen lds
    s_add_u32 m0, s3, 63488
    s_add_u32 s56, s100, 10752
    buffer_load_dwordx4 v235, s[20:23], s56 offen lds
    s_add_u32 m0, s3, 64512
    s_add_u32 s56, s100, 20992
    buffer_load_dwordx4 v234, s[20:23], s56 offen lds
    s_add_u32 m0, s3, 65536
    s_add_u32 s56, s100, 31232
    buffer_load_dwordx4 v235, s[20:23], s56 offen lds
    s_waitcnt vmcnt(16)
    s_barrier
    s_cmp_lg_u32 s38, 4
    s_cbranch_scc1 CL_NF
    v_lshlrev_b32 v6, 10, v1
    v_mov_b32 v7, s55
    s_mov_b64 exec, 15
    buffer_store_dword v7, v6, s[12:15], s75 offen sc1
    s_mov_b64 exec, -1
CL_NF:
    s_add_u32 m0, s101, 78848
    s_add_u32 s56, s99, 5120
    buffer_load_dwordx4 v248, s[12:15], s56 offen sc1 lds
    s_add_u32 m0, s101, 79936
    s_add_u32 s56, s99, 25600
    buffer_load_dwordx4 v248, s[12:15], s56 offen sc1 lds
    s_add_u32 m0, s101, 81024
    s_add_u32 s56, s99, 46080
    buffer_load_dwordx4 v248, s[12:15], s56 offen sc1 lds
    s_add_u32 m0, s101, 82112
    s_add_u32 s56, s99, 66560
    buffer_load_dwordx4 v248, s[12:15], s56 offen sc1 lds
    s_add_u32 m0, s3, 96256
    s_add_u32 s56, s100, 640
    buffer_load_dwordx4 v234, s[20:23], s56 offen lds
    s_add_u32 m0, s3, 97280
    s_add_u32 s56, s100, 10880
    buffer_load_dwordx4 v235, s[20:23], s56 offen lds
    s_add_u32 m0, s3, 98304
    s_add_u32 s56, s100, 21120
    buffer_load_dwordx4 v234, s[20:23], s56 offen lds
    s_add_u32 m0, s3, 99328
    s_add_u32 s56, s100, 31360
    buffer_load_dwordx4 v235, s[20:23], s56 offen lds
    s_waitcnt vmcnt(16)
    s_barrier
    s_add_u32 m0, s101, 112640
    s_add_u32 s56, s99, 6144
    buffer_load_dwordx4 v248, s[12:15], s56 offen sc1 lds
    s_add_u32 m0, s101, 113728
    s_add_u32 s56, s99, 26624
    buffer_load_dwordx4 v248, s[12:15], s56 offen sc1 lds
    s_add_u32 m0, s101, 114816
    s_add_u32 s56, s99, 47104
    buffer_load_dwordx4 v248, s[12:15], s56 offen sc1 lds
    s_add_u32 m0, s101, 115904
    s_add_u32 s56, s99, 67584
    buffer_load_dwordx4 v248, s[12:15], s56 offen sc1 lds
    s_add_u32 m0, s3, 130048
    s_add_u32 s56, s100, 768
    buffer_load_dwordx4 v234, s[20:23], s56 offen lds
    s_add_u32 m0, s3, 131072
    s_add_u32 s56, s100, 11008
    buffer_load_dwordx4 v235, s[20:23], s56 offen lds
    s_add_u32 m0, s3, 132096
    s_add_u32 s56, s100, 21248
    buffer_load_dwordx4 v234, s[20:23], s56 offen lds
    s_add_u32 m0, s3, 133120
    s_add_u32 s56, s100, 31488
    buffer_load_dwordx4 v235, s[20:23], s56 offen lds
    s_waitcnt vmcnt(16)
    s_barrier
    s_add_u32 m0, s101, 0
    s_add_u32 s56, s99, 7168
    buffer_load_dwordx4 v248, s[12:15], s56 offen sc1 lds
    s_add_u32 m0, s101, 1088
    s_add_u32 s56, s99, 27648
    buffer_load_dwordx4 v248, s[12:15], s56 offen sc1 lds
    s_add_u32 m0, s101, 2176
    s_add_u32 s56, s99, 48128
    buffer_load_dwordx4 v248, s[12:15], s56 offen sc1 lds
    s_add_u32 m0, s101, 3264
    s_add_u32 s56, s99, 68608
    buffer_load_dwordx4 v248, s[12:15], s56 offen sc1 lds
    s_add_u32 m0, s3, 17408
    s_add_u32 s56, s100, 896
    buffer_load_dwordx4 v234, s[20:23], s56 offen lds
    s_add_u32 m0, s3, 18432
    s_add_u32 s56, s100, 11136
    buffer_load_dwordx4 v235, s[20:23], s56 offen lds
    s_add_u32 m0, s3, 19456
    s_add_u32 s56, s100, 21376
    buffer_load_dwordx4 v234, s[20:23], s56 offen lds
    s_add_u32 m0, s3, 20480
    s_add_u32 s56, s100, 31616
    buffer_load_dwordx4 v235, s[20:23], s56 offen lds
    s_waitcnt vmcnt(16)
    s_barrier
    s_add_u32 m0, s101, 45056
    s_add_u32 s56, s99, 8192
    buffer_load_dwordx4 v248, s[12:15], s56 offen sc1 lds
    s_add_u32 m0, s101, 46144
    s_add_u32 s56, s99, 28672
    buffer_load_dwordx4 v248, s[12:15], s56 offen sc1 lds
    s_add_u32 m0, s101, 47232
    s_add_u32 s56, s99, 49152
    buffer_load_dwordx4 v248, s[12:15], s56 offen sc1 lds
    s_add_u32 m0, s101, 48320
    s_add_u32 s56, s99, 69632
    buffer_load_dwordx4 v248, s[12:15], s56 offen sc1 lds
    s_add_u32 m0, s3, 62464
    s_add_u32 s56, s100, 1024
    buffer_load_dwordx4 v234, s[20:23], s56 offen lds
    s_add_u32 m0, s3, 63488
    s_add_u32 s56, s100, 11264
    buffer_load_dwordx4 v235, s[20:23], s56 offen lds
    s_add_u32 m0, s3, 64512
    s_add_u32 s56, s100, 21504
    buffer_load_dwordx4 v234, s[20:23], s56 offen lds
    s_add_u32 m0, s3, 65536
    s_add_u32 s56, s100, 31744
    buffer_load_dwordx4 v235, s[20:23], s56 offen lds
    s_waitcnt vmcnt(16)
    s_barrier
    s_add_u32 m0, s101, 78848
    s_add_u32 s56, s99, 9216
    buffer_load_dwordx4 v248, s[12:15], s56 offen sc1 lds
    s_add_u32 m0, s101, 79936
    s_add_u32 s56, s99, 29696
    buffer_load_dwordx4 v248, s[12:15], s56 offen sc1 lds
    s_add_u32 m0, s101, 81024
    s_add_u32 s56, s99, 50176
    buffer_load_dwordx4 v248, s[12:15], s56 offen sc1 lds
    s_add_u32 m0, s101, 82112
    s_add_u32 s56, s99, 70656
    buffer_load_dwordx4 v248, s[12:15], s56 offen sc1 lds
    s_add_u32 m0, s3, 96256
    s_add_u32 s56, s100, 1152
    buffer_load_dwordx4 v234, s[20:23], s56 offen lds
    s_add_u32 m0, s3, 97280
    s_add_u32 s56, s100, 11392
    buffer_load_dwordx4 v235, s[20:23], s56 offen lds
    s_add_u32 m0, s3, 98304
    s_add_u32 s56, s100, 21632
    buffer_load_dwordx4 v234, s[20:23], s56 offen lds
    s_add_u32 m0, s3, 99328
    s_add_u32 s56, s100, 31872
    buffer_load_dwordx4 v235, s[20:23], s56 offen lds
    s_waitcnt vmcnt(16)
    s_barrier
    s_add_u32 m0, s101, 112640
    s_add_u32 s56, s99, 10240
    buffer_load_dwordx4 v248, s[12:15], s56 offen sc1 lds
    s_add_u32 m0, s101, 113728
    s_add_u32 s56, s99, 30720
    buffer_load_dwordx4 v248, s[12:15], s56 offen sc1 lds
    s_add_u32 m0, s101, 114816
    s_add_u32 s56, s99, 51200
    buffer_load_dwordx4 v248, s[12:15], s56 offen sc1 lds
    s_add_u32 m0, s101, 115904
    s_add_u32 s56, s99, 71680
    buffer_load_dwordx4 v248, s[12:15], s56 offen sc1 lds
    s_add_u32 m0, s3, 130048
    s_add_u32 s56, s100, 0
    buffer_load_dwordx4 v234, s[24:27], s56 offen lds
    s_add_u32 m0, s3, 131072
    s_add_u32 s56, s100, 10240
    buffer_load_dwordx4 v235, s[24:27], s56 offen lds
    s_add_u32 m0, s3, 132096
    s_add_u32 s56, s100, 20480
    buffer_load_dwordx4 v234, s[24:27], s56 offen lds
    s_add_u32 m0, s3, 133120
    s_add_u32 s56, s100, 30720
    buffer_load_dwordx4 v235, s[24:27], s56 offen lds
    s_waitcnt vmcnt(16)
    s_barrier
    s_add_u32 m0, s101, 0
    s_add_u32 s56, s99, 11264
    buffer_load_dwordx4 v248, s[12:15], s56 offen sc1 lds
    s_add_u32 m0, s101, 1088
    s_add_u32 s56, s99, 31744
    buffer_load_dwordx4 v248, s[12:15], s56 offen sc1 lds
    s_add_u32 m0, s101, 2176
    s_add_u32 s56, s99, 52224
    buffer_load_dwordx4 v248, s[12:15], s56 offen sc1 lds
    s_add_u32 m0, s101, 3264
    s_add_u32 s56, s99, 72704
    buffer_load_dwordx4 v248, s[12:15], s56 offen sc1 lds
    s_add_u32 m0, s3, 17408
    s_add_u32 s56, s100, 128
    buffer_load_dwordx4 v234, s[24:27], s56 offen lds
    s_add_u32 m0, s3, 18432
    s_add_u32 s56, s100, 10368
    buffer_load_dwordx4 v235, s[24:27], s56 offen lds
    s_add_u32 m0, s3, 19456
    s_add_u32 s56, s100, 20608
    buffer_load_dwordx4 v234, s[24:27], s56 offen lds
    s_add_u32 m0, s3, 20480
    s_add_u32 s56, s100, 30848
    buffer_load_dwordx4 v235, s[24:27], s56 offen lds
    s_waitcnt vmcnt(16)
    s_barrier
    s_add_u32 m0, s101, 45056
    s_add_u32 s56, s99, 12288
    buffer_load_dwordx4 v248, s[12:15], s56 offen sc1 lds
    s_add_u32 m0, s101, 46144
    s_add_u32 s56, s99, 32768
    buffer_load_dwordx4 v248, s[12:15], s56 offen sc1 lds
    s_add_u32 m0, s101, 47232
    s_add_u32 s56, s99, 53248
    buffer_load_dwordx4 v248, s[12:15], s56 offen sc1 lds
    s_add_u32 m0, s101, 48320
    s_add_u32 s56, s99, 73728
    buffer_load_dwordx4 v248, s[12:15], s56 offen sc1 lds
    s_add_u32 m0, s3, 62464
    s_add_u32 s56, s100, 256
    buffer_load_dwordx4 v234, s[24:27], s56 offen lds
    s_add_u32 m0, s3, 63488
    s_add_u32 s56, s100, 10496
    buffer_load_dwordx4 v235, s[24:27], s56 offen lds
    s_add_u32 m0, s3, 64512
    s_add_u32 s56, s100, 20736
    buffer_load_dwordx4 v234, s[24:27], s56 offen lds
    s_add_u32 m0, s3, 65536
    s_add_u32 s56, s100, 30976
    buffer_load_dwordx4 v235, s[24:27], s56 offen lds
    s_waitcnt vmcnt(16)
    s_barrier
    s_add_u32 m0, s101, 78848
    s_add_u32 s56, s99, 13312
    buffer_load_dwordx4 v248, s[12:15], s56 offen sc1 lds
    s_add_u32 m0, s101, 79936
    s_add_u32 s56, s99, 33792
    buffer_load_dwordx4 v248, s[12:15], s56 offen sc1 lds
    s_add_u32 m0, s101, 81024
    s_add_u32 s56, s99, 54272
    buffer_load_dwordx4 v248, s[12:15], s56 offen sc1 lds
    s_add_u32 m0, s101, 82112
    s_add_u32 s56, s99, 74752
    buffer_load_dwordx4 v248, s[12:15], s56 offen sc1 lds
    s_add_u32 m0, s3, 96256
    s_add_u32 s56, s100, 384
    buffer_load_dwordx4 v234, s[24:27], s56 offen lds
    s_add_u32 m0, s3, 97280
    s_add_u32 s56, s100, 10624
    buffer_load_dwordx4 v235, s[24:27], s56 offen lds
    s_add_u32 m0, s3, 98304
    s_add_u32 s56, s100, 20864
    buffer_load_dwordx4 v234, s[24:27], s56 offen lds
    s_add_u32 m0, s3, 99328
    s_add_u32 s56, s100, 31104
    buffer_load_dwordx4 v235, s[24:27], s56 offen lds
    s_waitcnt vmcnt(16)
    s_barrier
    s_add_u32 m0, s101, 112640
    s_add_u32 s56, s99, 14336
    buffer_load_dwordx4 v248, s[12:15], s56 offen sc1 lds
    s_add_u32 m0, s101, 113728
    s_add_u32 s56, s99, 34816
    buffer_load_dwordx4 v248, s[12:15], s56 offen sc1 lds
    s_add_u32 m0, s101, 114816
    s_add_u32 s56, s99, 55296
    buffer_load_dwordx4 v248, s[12:15], s56 offen sc1 lds
    s_add_u32 m0, s101, 115904
    s_add_u32 s56, s99, 75776
    buffer_load_dwordx4 v248, s[12:15], s56 offen sc1 lds
    s_add_u32 m0, s3, 130048
    s_add_u32 s56, s100, 512
    buffer_load_dwordx4 v234, s[24:27], s56 offen lds
    s_add_u32 m0, s3, 131072
    s_add_u32 s56, s100, 10752
    buffer_load_dwordx4 v235, s[24:27], s56 offen lds
    s_add_u32 m0, s3, 132096
    s_add_u32 s56, s100, 20992
    buffer_load_dwordx4 v234, s[24:27], s56 offen lds
    s_add_u32 m0, s3, 133120
    s_add_u32 s56, s100, 31232
    buffer_load_dwordx4 v235, s[24:27], s56 offen lds
    s_waitcnt vmcnt(16)
    s_barrier
    s_add_u32 m0, s101, 0
    s_add_u32 s56, s99, 15360
    buffer_load_dwordx4 v248, s[12:15], s56 offen sc1 lds
    s_add_u32 m0, s101, 1088
    s_add_u32 s56, s99, 35840
    buffer_load_dwordx4 v248, s[12:15], s56 offen sc1 lds
    s_add_u32 m0, s101, 2176
    s_add_u32 s56, s99, 56320
    buffer_load_dwordx4 v248, s[12:15], s56 offen sc1 lds
    s_add_u32 m0, s101, 3264
    s_add_u32 s56, s99, 76800
    buffer_load_dwordx4 v248, s[12:15], s56 offen sc1 lds
    s_add_u32 m0, s3, 17408
    s_add_u32 s56, s100, 640
    buffer_load_dwordx4 v234, s[24:27], s56 offen lds
    s_add_u32 m0, s3, 18432
    s_add_u32 s56, s100, 10880
    buffer_load_dwordx4 v235, s[24:27], s56 offen lds
    s_add_u32 m0, s3, 19456
    s_add_u32 s56, s100, 21120
    buffer_load_dwordx4 v234, s[24:27], s56 offen lds
    s_add_u32 m0, s3, 20480
    s_add_u32 s56, s100, 31360
    buffer_load_dwordx4 v235, s[24:27], s56 offen lds
    s_waitcnt vmcnt(16)
    s_barrier
    s_add_u32 m0, s101, 45056
    s_add_u32 s56, s99, 16384
    buffer_load_dwordx4 v248, s[12:15], s56 offen sc1 lds
    s_add_u32 m0, s101, 46144
    s_add_u32 s56, s99, 36864
    buffer_load_dwordx4 v248, s[12:15], s56 offen sc1 lds
    s_add_u32 m0, s101, 47232
    s_add_u32 s56, s99, 57344
    buffer_load_dwordx4 v248, s[12:15], s56 offen sc1 lds
    s_add_u32 m0, s101, 48320
    s_add_u32 s56, s99, 77824
    buffer_load_dwordx4 v248, s[12:15], s56 offen sc1 lds
    s_add_u32 m0, s3, 62464
    s_add_u32 s56, s100, 768
    buffer_load_dwordx4 v234, s[24:27], s56 offen lds
    s_add_u32 m0, s3, 63488
    s_add_u32 s56, s100, 11008
    buffer_load_dwordx4 v235, s[24:27], s56 offen lds
    s_add_u32 m0, s3, 64512
    s_add_u32 s56, s100, 21248
    buffer_load_dwordx4 v234, s[24:27], s56 offen lds
    s_add_u32 m0, s3, 65536
    s_add_u32 s56, s100, 31488
    buffer_load_dwordx4 v235, s[24:27], s56 offen lds
    s_waitcnt vmcnt(16)
    s_barrier
    s_add_u32 m0, s101, 78848
    s_add_u32 s56, s99, 17408
    buffer_load_dwordx4 v248, s[12:15], s56 offen sc1 lds
    s_add_u32 m0, s101, 79936
    s_add_u32 s56, s99, 37888
    buffer_load_dwordx4 v248, s[12:15], s56 offen sc1 lds
    s_add_u32 m0, s101, 81024
    s_add_u32 s56, s99, 58368
    buffer_load_dwordx4 v248, s[12:15], s56 offen sc1 lds
    s_add_u32 m0, s101, 82112
    s_add_u32 s56, s99, 78848
    buffer_load_dwordx4 v248, s[12:15], s56 offen sc1 lds
    s_add_u32 m0, s3, 96256
    s_add_u32 s56, s100, 896
    buffer_load_dwordx4 v234, s[24:27], s56 offen lds
    s_add_u32 m0, s3, 97280
    s_add_u32 s56, s100, 11136
    buffer_load_dwordx4 v235, s[24:27], s56 offen lds
    s_add_u32 m0, s3, 98304
    s_add_u32 s56, s100, 21376
    buffer_load_dwordx4 v234, s[24:27], s56 offen lds
    s_add_u32 m0, s3, 99328
    s_add_u32 s56, s100, 31616
    buffer_load_dwordx4 v235, s[24:27], s56 offen lds
    s_waitcnt vmcnt(16)
    s_barrier
    s_add_u32 m0, s101, 112640
    s_add_u32 s56, s99, 18432
    buffer_load_dwordx4 v248, s[12:15], s56 offen sc1 lds
    s_add_u32 m0, s101, 113728
    s_add_u32 s56, s99, 38912
    buffer_load_dwordx4 v248, s[12:15], s56 offen sc1 lds
    s_add_u32 m0, s101, 114816
    s_add_u32 s56, s99, 59392
    buffer_load_dwordx4 v248, s[12:15], s56 offen sc1 lds
    s_add_u32 m0, s101, 115904
    s_add_u32 s56, s99, 79872
    buffer_load_dwordx4 v248, s[12:15], s56 offen sc1 lds
    s_add_u32 m0, s3, 130048
    s_add_u32 s56, s100, 1024
    buffer_load_dwordx4 v234, s[24:27], s56 offen lds
    s_add_u32 m0, s3, 131072
    s_add_u32 s56, s100, 11264
    buffer_load_dwordx4 v235, s[24:27], s56 offen lds
    s_add_u32 m0, s3, 132096
    s_add_u32 s56, s100, 21504
    buffer_load_dwordx4 v234, s[24:27], s56 offen lds
    s_add_u32 m0, s3, 133120
    s_add_u32 s56, s100, 31744
    buffer_load_dwordx4 v235, s[24:27], s56 offen lds
    s_waitcnt vmcnt(16)
    s_barrier
    s_add_u32 m0, s101, 0
    s_add_u32 s56, s99, 19456
    buffer_load_dwordx4 v248, s[12:15], s56 offen sc1 lds
    s_add_u32 m0, s101, 1088
    s_add_u32 s56, s99, 39936
    buffer_load_dwordx4 v248, s[12:15], s56 offen sc1 lds
    s_add_u32 m0, s101, 2176
    s_add_u32 s56, s99, 60416
    buffer_load_dwordx4 v248, s[12:15], s56 offen sc1 lds
    s_add_u32 m0, s101, 3264
    s_add_u32 s56, s99, 80896
    buffer_load_dwordx4 v248, s[12:15], s56 offen sc1 lds
    s_add_u32 m0, s3, 17408
    s_add_u32 s56, s100, 1152
    buffer_load_dwordx4 v234, s[24:27], s56 offen lds
    s_add_u32 m0, s3, 18432
    s_add_u32 s56, s100, 11392
    buffer_load_dwordx4 v235, s[24:27], s56 offen lds
    s_add_u32 m0, s3, 19456
    s_add_u32 s56, s100, 21632
    buffer_load_dwordx4 v234, s[24:27], s56 offen lds
    s_add_u32 m0, s3, 20480
    s_add_u32 s56, s100, 31872
    buffer_load_dwordx4 v235, s[24:27], s56 offen lds
    s_waitcnt vmcnt(16)
    s_barrier
    s_waitcnt vmcnt(8)
    s_barrier
    s_cmp_lg_u32 s38, 5
    s_cbranch_scc1 CL_ND
    s_waitcnt vmcnt(0)
    s_barrier
    s_mov_b32 s10, 0
    s_mov_b64 exec, 0
    s_branch CC_EPI
CL_ND:
    s_waitcnt vmcnt(0)
    s_barrier
    s_branch PK_FIN
CC_COMP:
    s_mov_b32 s53, 20
    s_branch CC_LOOP_IN
CC_LOOP:
    s_barrier
CC_LOOP_IN:
    v_mfma_f32_32x32x16_bf16 v[128:143], v[208:211], v[216:219], v[128:143]
    ds_read_b64_tr_b16 v[192:193], v228 offset:0
    ds_read_b64_tr_b16 v[194:195], v228 offset:64
    ds_read_b128 v[200:203], v224 offset:0
    v_mfma_f32_32x32x16_bf16 v[160:175], v[212:215], v[216:219], v[160:175]
    ds_read_b64_tr_b16 v[196:197], v228 offset:4352
    ds_read_b64_tr_b16 v[198:199], v228 offset:4416
    ds_read_b128 v[204:207], v224 offset:4096
    v_mfma_f32_32x32x16_bf16 v[144:159], v[208:211], v[220:223], v[144:159]
    s_add_u32 s56, s54, 33792
    s_cmp_eq_u32 s54, 0
    s_cselect_b32 s56, 45056, s56
    v_mfma_f32_32x32x16_bf16 v[176:191], v[212:215], v[220:223], v[176:191]
    s_waitcnt lgkmcnt(0)
    v_mfma_f32_32x32x16_bf16 v[128:143], v[192:195], v[200:203], v[128:143]
    ds_read_b64_tr_b16 v[208:209], v228 offset:256
    ds_read_b64_tr_b16 v[210:211], v228 offset:320
    ds_read_b128 v[216:219], v225 offset:0
    v_mfma_f32_32x32x16_bf16 v[160:175], v[196:199], v[200:203], v[160:175]
    ds_read_b64_tr_b16 v[212:213], v228 offset:4608
    ds_read_b64_tr_b16 v[214:215], v228 offset:4672
    ds_read_b128 v[220:223], v225 offset:4096
    v_mfma_f32_32x32x16_bf16 v[144:159], v[192:195], v[204:207], v[144:159]
    s_cmp_eq_u32 s54, 112640
    s_cselect_b32 s54, 0, s56
    v_add_u32 v224, s54, v229
    v_add_u32 v225, s54, v230
    v_mfma_f32_32x32x16_bf16 v[176:191], v[196:199], v[204:207], v[176:191]
    s_waitcnt lgkmcnt(0)
    v_mfma_f32_32x32x16_bf16 v[128:143], v[208:211], v[216:219], v[128:143]
    ds_read_b64_tr_b16 v[192:193], v228 offset:512
    ds_read_b64_tr_b16 v[194:195], v228 offset:576
    ds_read_b128 v[200:203], v226 offset:0
    v_mfma_f32_32x32x16_bf16 v[160:175], v[212:215], v[216:219], v[160:175]
    ds_read_b64_tr_b16 v[196:197], v228 offset:4864
    ds_read_b64_tr_b16 v[198:199], v228 offset:4928
    ds_read_b128 v[204:207], v226 offset:4096
    v_mfma_f32_32x32x16_bf16 v[144:159], v[208:211], v[220:223], v[144:159]
    v_add_u32 v226, s54, v231
    s_cmp_lg_u32 s53, 19
    s_cbranch_scc1 CC_NW
    s_waitcnt vmcnt(0)
CC_NW:
    v_mfma_f32_32x32x16_bf16 v[176:191], v[212:215], v[220:223], v[176:191]
    s_waitcnt lgkmcnt(0)
    v_mfma_f32_32x32x16_bf16 v[128:143], v[192:195], v[200:203], v[128:143]
    ds_read_b64_tr_b16 v[208:209], v228 offset:768
    ds_read_b64_tr_b16 v[210:211], v228 offset:832
    ds_read_b128 v[216:219], v227 offset:0
    v_mfma_f32_32x32x16_bf16 v[160:175], v[196:199], v[200:203], v[160:175]
    ds_read_b64_tr_b16 v[212:213], v228 offset:5120
    ds_read_b64_tr_b16 v[214:215], v228 offset:5184
    ds_read_b128 v[220:223], v227 offset:4096
    v_mfma_f32_32x32x16_bf16 v[144:159], v[192:195], v[204:207], v[144:159]
    v_add_u32 v227, s54, v232
    v_add_u32 v228, s54, v233
    s_sub_u32 s53, s53, 1
    s_cmp_lg_u32 s53, 0
    v_mfma_f32_32x32x16_bf16 v[176:191], v[196:199], v[204:207], v[176:191]
    s_waitcnt lgkmcnt(0)
    s_cbranch_scc1 CC_LOOP
    v_mfma_f32_32x32x16_bf16 v[128:143], v[208:211], v[216:219], v[128:143]
    v_mfma_f32_32x32x16_bf16 v[160:175], v[212:215], v[216:219], v[160:175]
    v_mfma_f32_32x32x16_bf16 v[144:159], v[208:211], v[220:223], v[144:159]
    v_mfma_f32_32x32x16_bf16 v[176:191], v[212:215], v[220:223], v[176:191]
    s_mul_i32 s10, s40, 5120
    s_lshl_b32 s56, s41, 2
    s_add_u32 s10, s10, s56
    s_add_u32 s10, s10, 2560
    v_add_u32 v2, 128, v234
    s_nop 7
    .p2align 3
CC_EPI:
    ds_write2st64_b32 v234, v128, v129 offset0:0 offset1:1
    ds_write2st64_b32 v234, v130, v131 offset0:2 offset1:3
    ds_write2st64_b32 v234, v132, v133 offset0:8 offset1:9
    ds_write2st64_b32 v234, v134, v135 offset0:10 offset1:11
    ds_write2st64_b32 v234, v136, v137 offset0:16 offset1:17
    ds_write2st64_b32 v234, v138, v139 offset0:18 offset1:19
    ds_write2st64_b32 v234, v140, v141 offset0:24 offset1:25
    ds_write2st64_b32 v234, v142, v143 offset0:26 offset1:27
    ds_write2st64_b32 v2, v144, v145 offset0:0 offset1:1
    ds_write2st64_b32 v2, v146, v147 offset0:2 offset1:3
    ds_write2st64_b32 v2, v148, v149 offset0:8 offset1:9
    ds_write2st64_b32 v2, v150, v151 offset0:10 offset1:11
    ds_write2st64_b32 v2, v152, v153 offset0:16 offset1:17
    ds_write2st64_b32 v2, v154, v155 offset0:18 offset1:19
    ds_write2st64_b32 v2, v156, v157 offset0:24 offset1:25
    ds_write2st64_b32 v2, v158, v159 offset0:26 offset1:27
    s_waitcnt lgkmcnt(0)
    ds_read_b128 v[16:19], v236 offset:0
    ds_read_b128 v[20:23], v236 offset:1024
    ds_read_b128 v[24:27], v236 offset:2048
    ds_read_b128 v[28:31], v236 offset:3072
    ds_read_b128 v[32:35], v236 offset:4096
    ds_read_b128 v[36:39], v236 offset:5120
    ds_read_b128 v[40:43], v236 offset:6144
    ds_read_b128 v[44:47], v236 offset:7168
    ds_write2st64_b32 v234, v160, v161 offset0:32 offset1:33
    ds_write2st64_b32 v234, v162, v163 offset0:34 offset1:35
    s_add_u32 s56, s10, 0
    s_waitcnt lgkmcnt(9)
    buffer_store_dwordx4 v[16:19], v235, s[32:35], s56 offen nt
    ds_write2st64_b32 v234, v164, v165 offset0:40 offset1:41
    ds_write2st64_b32 v234, v166, v167 offset0:42 offset1:43
    s_add_u32 s56, s10, 20480
    s_waitcnt lgkmcnt(10)
    buffer_store_dwordx4 v[20:23], v235, s[32:35], s56 offen nt
    ds_write2st64_b32 v234, v168, v169 offset0:48 offset1:49
    ds_write2st64_b32 v234, v170, v171 offset0:50 offset1:51
    s_add_u32 s56, s10, 40960
    s_waitcnt lgkmcnt(11)
    buffer_store_dwordx4 v[24:27], v235, s[32:35], s56 offen nt
    ds_write2st64_b32 v234, v172, v173 offset0:56 offset1:57
    ds_write2st64_b32 v234, v174, v175 offset0:58 offset1:59
    s_add_u32 s56, s10, 61440
    s_waitcnt lgkmcnt(12)
    buffer_store_dwordx4 v[28:31], v235, s[32:35], s56 offen nt
    ds_write2st64_b32 v2, v176, v177 offset0:32 offset1:33
    ds_write2st64_b32 v2, v178, v179 offset0:34 offset1:35
    s_add_u32 s56, s10, 81920
    s_waitcnt lgkmcnt(13)
    buffer_store_dwordx4 v[32:35], v235, s[32:35], s56 offen nt
    ds_write2st64_b32 v2, v180, v181 offset0:40 offset1:41
    ds_write2st64_b32 v2, v182, v183 offset0:42 offset1:43
    s_add_u32 s56, s10, 102400
    s_waitcnt lgkmcnt(14)
    buffer_store_dwordx4 v[36:39], v235, s[32:35], s56 offen nt
    ds_write2st64_b32 v2, v184, v185 offset0:48 offset1:49
    ds_write2st64_b32 v2, v186, v187 offset0:50 offset1:51
    s_add_u32 s56, s10, 122880
    s_waitcnt lgkmcnt(15)
    buffer_store_dwordx4 v[40:43], v235, s[32:35], s56 offen nt
    ds_write2st64_b32 v2, v188, v189 offset0:56 offset1:57
    ds_write2st64_b32 v2, v190, v191 offset0:58 offset1:59
    s_add_u32 s56, s10, 143360
    s_waitcnt lgkmcnt(15)
    buffer_store_dwordx4 v[44:47], v235, s[32:35], s56 offen nt
    s_waitcnt lgkmcnt(0)
    ds_read_b128 v[128:131], v236 offset:8192
    ds_read_b128 v[132:135], v236 offset:9216
    ds_read_b128 v[136:139], v236 offset:10240
    ds_read_b128 v[140:143], v236 offset:11264
    ds_read_b128 v[144:147], v236 offset:12288
    ds_read_b128 v[148:151], v236 offset:13312
    ds_read_b128 v[152:155], v236 offset:14336
    ds_read_b128 v[156:159], v236 offset:15360
    s_add_u32 s56, s10, 163840
    s_waitcnt lgkmcnt(7)
    buffer_store_dwordx4 v[128:131], v235, s[32:35], s56 offen nt
    s_add_u32 s56, s10, 184320
    s_waitcnt lgkmcnt(6)
    buffer_store_dwordx4 v[132:135], v235, s[32:35], s56 offen nt
    s_add_u32 s56, s10, 204800
    s_waitcnt lgkmcnt(5)
    buffer_store_dwordx4 v[136:139], v235, s[32:35], s56 offen nt
    s_add_u32 s56, s10, 225280
    s_waitcnt lgkmcnt(4)
    buffer_store_dwordx4 v[140:143], v235, s[32:35], s56 offen nt
    s_add_u32 s56, s10, 245760
    s_waitcnt lgkmcnt(3)
    buffer_store_dwordx4 v[144:147], v235, s[32:35], s56 offen nt
    s_add_u32 s56, s10, 266240
    s_waitcnt lgkmcnt(2)
    buffer_store_dwordx4 v[148:151], v235, s[32:35], s56 offen nt
    s_add_u32 s56, s10, 286720
    s_waitcnt lgkmcnt(1)
    buffer_store_dwordx4 v[152:155], v235, s[32:35], s56 offen nt
    s_add_u32 s56, s10, 307200
    s_waitcnt lgkmcnt(0)
    buffer_store_dwordx4 v[156:159], v235, s[32:35], s56 offen nt
PK_FIN:
PK_END:
    s_endpgm
.section .rodata,"a"
.p2align 6
.amdhsa_kernel concat_heads__softmax_full_mha__ssm_conv_s5__prompt_kernel
  .amdhsa_next_free_vgpr 256
  .amdhsa_next_free_sgpr 102
  .amdhsa_accum_offset 256
  .amdhsa_group_segment_fixed_size 0
  .amdhsa_kernarg_size 120
  .amdhsa_user_sgpr_count 2
  .amdhsa_user_sgpr_kernarg_segment_ptr 1
  .amdhsa_system_sgpr_workgroup_id_x 1
.end_amdhsa_kernel
```
